```python
import torch

def _softmax(x, axis=-1):
    return torch.softmax(x, dim=axis)
def _gelu(x):
    return torch.nn.functional.gelu(x, approximate="tanh")
def _silu(x):
    return torch.nn.functional.silu(x)
def _sigmoid(x):
    return torch.sigmoid(x)
def _layernorm(x, axis=-1, eps=1e-5):
    m = x.mean(dim=axis, keepdim=True)
    v = x.var(dim=axis, keepdim=True, unbiased=False)
    return (x - m) / torch.sqrt(v + eps)
def _scatter_add(tgt, idx, src, axis=0):
    return tgt.clone().index_add_(axis, idx, src)
def _segment_sum(src, seg, n):
    out = torch.zeros((n,) + src.shape[1:], dtype=src.dtype)
    return out.index_add_(0, seg, src)
def _pad(x, pw):
    flat = tuple(v for pair in reversed(pw) for v in pair)
    return torch.nn.functional.pad(x, flat)

kernel_name = 'standalone__molecular_angular_gemnet__graph'

def setup_inputs():

    _w = (lambda a: (lambda t: t.to(torch.bfloat16) if t.is_floating_point() else t)(torch.as_tensor(a)))
    N, deg, De, L = 25000, 16, 16, 1
    E = N * deg
    T = E * deg
    NR = 8
    dist = torch.rand(E).to(float)
    angle = (torch.rand(T) * torch.pi).to(float)
    centers = torch.linspace(0.0, 1.0, NR).to(float)
    ang_freq = torch.arange(1, L + 1).to(float)
    return {
        "m": _w((lambda *s: torch.randn(*s, dtype=torch.bfloat16) * 0.05)(E, De)),
        "idx_in": _w((lambda lo, hi, *s: torch.randint(lo, hi, s))(0, E, T).to(torch.int64)),
        "idx_out": _w((lambda lo, hi, *s: torch.randint(lo, hi, s))(0, E, T).to(torch.int64)),
        "dist": _w(dist),
        "angle": _w(angle),
        "centers": _w(centers),
        "ang_freq": _w(ang_freq),
        "w_rbf": _w((lambda *s: torch.randn(*s, dtype=torch.bfloat16) * 0.2)(NR, De)),
        "w_sbf": _w((lambda *s: torch.randn(*s, dtype=torch.bfloat16) * 0.2)(NR * L, De)),
        "w_down": _w((lambda *s: torch.randn(*s, dtype=torch.bfloat16) * 0.2)(De, De)),
        "w_up": _w((lambda *s: torch.randn(*s, dtype=torch.bfloat16) * 0.2)(De, De)),
    }

def reference(m, idx_in, idx_out, dist, angle, centers, ang_freq, w_rbf, w_sbf, w_down, w_up):
    E, De = m.shape[0], m.shape[1]
    NR = centers.shape[0]
    L = ang_freq.shape[0]
    rbf = torch.exp(-10.0 * (dist[:, None] - centers[None, :]) ** 2)
    cbf = torch.cos(ang_freq[None, :] * angle[:, None])
    rbf_t = rbf[idx_out]
    sbf = torch.reshape(rbf_t[:, :, None] * cbf[:, None, :], (-1, NR * L))
    x = (m[idx_in] @ w_down) * (sbf @ w_sbf)
    agg = _segment_sum(x, idx_out, E)
    return m + (agg @ w_up) * (rbf @ w_rbf)
```

```asm
; @launch kernel=gem_part_kernel grid=(256,1,1) block=(1024,1,1) lds=158720
; @launch kernel=gem_gath_kernel grid=(256,1,1) block=(960,1,1) lds=162944
.amdgcn_target "amdgcn-amd-amdhsa--gfx950"
.text
.globl gem_part_kernel
.p2align 8
.type gem_part_kernel,@function
gem_part_kernel:
    s_cmp_ge_u32 s2, 256
    s_cbranch_scc1 K1_end
    s_load_dwordx4 s[4:7], s[0:1], 8
    s_load_dwordx2 s[8:9], s[0:1], 32
    s_load_dwordx2 s[10:11], s[0:1], 48
    s_load_dwordx2 s[12:13], s[0:1], 0
    s_load_dwordx2 s[14:15], s[0:1], 104
    v_lshlrev_b32 v1, 4, v0
    v_lshlrev_b32 v2, 3, v0
    v_lshlrev_b32 v3, 2, v0
    v_lshlrev_b32 v4, 1, v0
    v_lshrrev_b32 v5, 6, v0
    v_mov_b32 v6, 0
    v_mov_b32 v7, 0
    v_readfirstlane_b32 s3, v5
    ds_write_b64 v2, v[6:7] offset:0
    s_mul_i32 s40, s2, 100000
    s_mul_i32 s41, s2, 50000
    s_mul_i32 s42, s2, 150016
    s_waitcnt lgkmcnt(0)
    s_add_u32 s16, s4, s40
    s_addc_u32 s17, s5, 0
    s_mov_b32 s18, 100000
    s_mov_b32 s19, 0x20000
    s_add_u32 s20, s6, s40
    s_addc_u32 s21, s7, 0
    s_mov_b32 s22, 100000
    s_mov_b32 s23, 0x20000
    s_add_u32 s24, s8, s41
    s_addc_u32 s25, s9, 0
    s_mov_b32 s26, 50000
    s_mov_b32 s27, 0x20000
    s_add_u32 s28, s14, s42
    s_addc_u32 s29, s15, 0
    s_mov_b32 s30, 150000
    s_mov_b32 s31, 0x20000
    s_add_u32 s32, s14, 41943040
    s_addc_u32 s33, s15, 0
    s_mov_b32 s34, 2097152
    s_mov_b32 s35, 0x20000
    s_mov_b32 s36, s10
    s_mov_b32 s37, s11
    s_mov_b32 s38, 2
    s_mov_b32 s39, 0x20000
    s_cmp_lt_u32 s3, 4
    s_cbranch_scc1 K1_prio
    s_setprio 1
    s_cmp_lt_u32 s3, 8
    s_cbranch_scc1 K1_prio
    s_setprio 2
    s_cmp_lt_u32 s3, 12
    s_cbranch_scc1 K1_prio
    s_setprio 3
K1_prio:
    s_mov_b32 s43, 0
    buffer_load_dwordx4 v[10:13], v1, s[20:23], s43 offen nt
    buffer_load_dwordx4 v[36:39], v1, s[16:19], s43 offen nt
    s_mov_b32 s44, 4294887296
    s_mov_b32 s45, 0x07f00000
    s_mov_b32 s46, 0x000f0000
    s_movk_i32 s61, 0x380
    v_mov_b32 v8, 1
    s_movk_i32 s47, 424
    v_cmp_gt_u32 s[48:49], s47, v0
    s_barrier
    s_waitcnt vmcnt(0)
    s_mov_b32 s43, 16384
    buffer_load_dwordx4 v[14:17], v1, s[20:23], s43 offen nt
    buffer_load_dwordx4 v[40:43], v1, s[16:19], s43 offen nt
    v_lshrrev_b32 v76, 7, v36
    v_lshrrev_b32 v78, 2, v10
    v_mul_u32_u24 v76, 6711, v76
    v_lshrrev_b32 v79, 8, v10
    v_and_b32 v78, 0x3fc, v78
    v_lshrrev_b32 v76, 22, v76
    v_bfi_b32 v79, 15, v10, v79
    v_lshl_or_b32 v78, v76, 10, v78
    v_mad_i32_i24 v36, v76, s44, v36
    ds_add_u32 v78, v8 offset:0
    v_lshl_or_b32 v10, v79, 16, v78
    v_lshrrev_b32 v77, 16, v36
    v_lshl_or_b32 v10, v77, 31, v10
    v_lshrrev_b32 v76, 7, v37
    v_lshrrev_b32 v78, 2, v11
    v_mul_u32_u24 v76, 6711, v76
    v_lshrrev_b32 v79, 8, v11
    v_and_b32 v78, 0x3fc, v78
    v_lshrrev_b32 v76, 22, v76
    v_bfi_b32 v79, 15, v11, v79
    v_lshl_or_b32 v78, v76, 10, v78
    v_mad_i32_i24 v37, v76, s44, v37
    ds_add_u32 v78, v8 offset:0
    v_lshl_or_b32 v11, v79, 16, v78
    v_lshrrev_b32 v77, 16, v37
    v_lshl_or_b32 v11, v77, 31, v11
    v_lshrrev_b32 v76, 7, v38
    v_lshrrev_b32 v78, 2, v12
    v_mul_u32_u24 v76, 6711, v76
    v_lshrrev_b32 v79, 8, v12
    v_and_b32 v78, 0x3fc, v78
    v_lshrrev_b32 v76, 22, v76
    v_bfi_b32 v79, 15, v12, v79
    v_lshl_or_b32 v78, v76, 10, v78
    v_mad_i32_i24 v38, v76, s44, v38
    ds_add_u32 v78, v8 offset:0
    v_lshl_or_b32 v12, v79, 16, v78
    v_lshrrev_b32 v77, 16, v38
    v_lshl_or_b32 v12, v77, 31, v12
    v_lshrrev_b32 v76, 7, v39
    v_lshrrev_b32 v78, 2, v13
    v_mul_u32_u24 v76, 6711, v76
    v_lshrrev_b32 v79, 8, v13
    v_and_b32 v78, 0x3fc, v78
    v_lshrrev_b32 v76, 22, v76
    v_bfi_b32 v79, 15, v13, v79
    v_lshl_or_b32 v78, v76, 10, v78
    v_mad_i32_i24 v39, v76, s44, v39
    ds_add_u32 v78, v8 offset:0
    v_lshl_or_b32 v13, v79, 16, v78
    v_lshrrev_b32 v77, 16, v39
    v_lshl_or_b32 v13, v77, 31, v13
    s_waitcnt vmcnt(0)
    s_mov_b32 s43, 32768
    buffer_load_dwordx4 v[18:21], v1, s[20:23], s43 offen nt
    buffer_load_dwordx4 v[44:47], v1, s[16:19], s43 offen nt
    v_lshrrev_b32 v76, 7, v40
    v_lshrrev_b32 v78, 2, v14
    v_mul_u32_u24 v76, 6711, v76
    v_lshrrev_b32 v79, 8, v14
    v_and_b32 v78, 0x3fc, v78
    v_lshrrev_b32 v76, 22, v76
    v_bfi_b32 v79, 15, v14, v79
    v_lshl_or_b32 v78, v76, 10, v78
    v_mad_i32_i24 v40, v76, s44, v40
    ds_add_u32 v78, v8 offset:0
    v_lshl_or_b32 v14, v79, 16, v78
    v_lshrrev_b32 v77, 16, v40
    v_lshl_or_b32 v14, v77, 31, v14
    v_lshrrev_b32 v76, 7, v41
    v_lshrrev_b32 v78, 2, v15
    v_mul_u32_u24 v76, 6711, v76
    v_lshrrev_b32 v79, 8, v15
    v_and_b32 v78, 0x3fc, v78
    v_lshrrev_b32 v76, 22, v76
    v_bfi_b32 v79, 15, v15, v79
    v_lshl_or_b32 v78, v76, 10, v78
    v_mad_i32_i24 v41, v76, s44, v41
    ds_add_u32 v78, v8 offset:0
    v_lshl_or_b32 v15, v79, 16, v78
    v_lshrrev_b32 v77, 16, v41
    v_lshl_or_b32 v15, v77, 31, v15
    v_lshrrev_b32 v76, 7, v42
    v_lshrrev_b32 v78, 2, v16
    v_mul_u32_u24 v76, 6711, v76
    v_lshrrev_b32 v79, 8, v16
    v_and_b32 v78, 0x3fc, v78
    v_lshrrev_b32 v76, 22, v76
    v_bfi_b32 v79, 15, v16, v79
    v_lshl_or_b32 v78, v76, 10, v78
    v_mad_i32_i24 v42, v76, s44, v42
    ds_add_u32 v78, v8 offset:0
    v_lshl_or_b32 v16, v79, 16, v78
    v_lshrrev_b32 v77, 16, v42
    v_lshl_or_b32 v16, v77, 31, v16
    v_lshrrev_b32 v76, 7, v43
    v_lshrrev_b32 v78, 2, v17
    v_mul_u32_u24 v76, 6711, v76
    v_lshrrev_b32 v79, 8, v17
    v_and_b32 v78, 0x3fc, v78
    v_lshrrev_b32 v76, 22, v76
    v_bfi_b32 v79, 15, v17, v79
    v_lshl_or_b32 v78, v76, 10, v78
    v_mad_i32_i24 v43, v76, s44, v43
    ds_add_u32 v78, v8 offset:0
    v_lshl_or_b32 v17, v79, 16, v78
    v_lshrrev_b32 v77, 16, v43
    v_lshl_or_b32 v17, v77, 31, v17
    s_waitcnt vmcnt(0)
    s_mov_b32 s43, 49152
    buffer_load_dwordx4 v[22:25], v1, s[20:23], s43 offen nt
    buffer_load_dwordx4 v[48:51], v1, s[16:19], s43 offen nt
    v_lshrrev_b32 v76, 7, v44
    v_lshrrev_b32 v78, 2, v18
    v_mul_u32_u24 v76, 6711, v76
    v_lshrrev_b32 v79, 8, v18
    v_and_b32 v78, 0x3fc, v78
    v_lshrrev_b32 v76, 22, v76
    v_bfi_b32 v79, 15, v18, v79
    v_lshl_or_b32 v78, v76, 10, v78
    v_mad_i32_i24 v44, v76, s44, v44
    ds_add_u32 v78, v8 offset:0
    v_lshl_or_b32 v18, v79, 16, v78
    v_lshrrev_b32 v77, 16, v44
    v_lshl_or_b32 v18, v77, 31, v18
    v_lshrrev_b32 v76, 7, v45
    v_lshrrev_b32 v78, 2, v19
    v_mul_u32_u24 v76, 6711, v76
    v_lshrrev_b32 v79, 8, v19
    v_and_b32 v78, 0x3fc, v78
    v_lshrrev_b32 v76, 22, v76
    v_bfi_b32 v79, 15, v19, v79
    v_lshl_or_b32 v78, v76, 10, v78
    v_mad_i32_i24 v45, v76, s44, v45
    ds_add_u32 v78, v8 offset:0
    v_lshl_or_b32 v19, v79, 16, v78
    v_lshrrev_b32 v77, 16, v45
    v_lshl_or_b32 v19, v77, 31, v19
    v_lshrrev_b32 v76, 7, v46
    v_lshrrev_b32 v78, 2, v20
    v_mul_u32_u24 v76, 6711, v76
    v_lshrrev_b32 v79, 8, v20
    v_and_b32 v78, 0x3fc, v78
    v_lshrrev_b32 v76, 22, v76
    v_bfi_b32 v79, 15, v20, v79
    v_lshl_or_b32 v78, v76, 10, v78
    v_mad_i32_i24 v46, v76, s44, v46
    ds_add_u32 v78, v8 offset:0
    v_lshl_or_b32 v20, v79, 16, v78
    v_lshrrev_b32 v77, 16, v46
    v_lshl_or_b32 v20, v77, 31, v20
    v_lshrrev_b32 v76, 7, v47
    v_lshrrev_b32 v78, 2, v21
    v_mul_u32_u24 v76, 6711, v76
    v_lshrrev_b32 v79, 8, v21
    v_and_b32 v78, 0x3fc, v78
    v_lshrrev_b32 v76, 22, v76
    v_bfi_b32 v79, 15, v21, v79
    v_lshl_or_b32 v78, v76, 10, v78
    v_mad_i32_i24 v47, v76, s44, v47
    ds_add_u32 v78, v8 offset:0
    v_lshl_or_b32 v21, v79, 16, v78
    v_lshrrev_b32 v77, 16, v47
    v_lshl_or_b32 v21, v77, 31, v21
    s_waitcnt vmcnt(0)
    s_mov_b32 s43, 65536
    buffer_load_dwordx4 v[26:29], v1, s[20:23], s43 offen nt
    buffer_load_dwordx4 v[52:55], v1, s[16:19], s43 offen nt
    v_lshrrev_b32 v76, 7, v48
    v_lshrrev_b32 v78, 2, v22
    v_mul_u32_u24 v76, 6711, v76
    v_lshrrev_b32 v79, 8, v22
    v_and_b32 v78, 0x3fc, v78
    v_lshrrev_b32 v76, 22, v76
    v_bfi_b32 v79, 15, v22, v79
    v_lshl_or_b32 v78, v76, 10, v78
    v_mad_i32_i24 v48, v76, s44, v48
    ds_add_u32 v78, v8 offset:0
    v_lshl_or_b32 v22, v79, 16, v78
    v_lshrrev_b32 v77, 16, v48
    v_lshl_or_b32 v22, v77, 31, v22
    v_lshrrev_b32 v76, 7, v49
    v_lshrrev_b32 v78, 2, v23
    v_mul_u32_u24 v76, 6711, v76
    v_lshrrev_b32 v79, 8, v23
    v_and_b32 v78, 0x3fc, v78
    v_lshrrev_b32 v76, 22, v76
    v_bfi_b32 v79, 15, v23, v79
    v_lshl_or_b32 v78, v76, 10, v78
    v_mad_i32_i24 v49, v76, s44, v49
    ds_add_u32 v78, v8 offset:0
    v_lshl_or_b32 v23, v79, 16, v78
    v_lshrrev_b32 v77, 16, v49
    v_lshl_or_b32 v23, v77, 31, v23
    v_lshrrev_b32 v76, 7, v50
    v_lshrrev_b32 v78, 2, v24
    v_mul_u32_u24 v76, 6711, v76
    v_lshrrev_b32 v79, 8, v24
    v_and_b32 v78, 0x3fc, v78
    v_lshrrev_b32 v76, 22, v76
    v_bfi_b32 v79, 15, v24, v79
    v_lshl_or_b32 v78, v76, 10, v78
    v_mad_i32_i24 v50, v76, s44, v50
    ds_add_u32 v78, v8 offset:0
    v_lshl_or_b32 v24, v79, 16, v78
    v_lshrrev_b32 v77, 16, v50
    v_lshl_or_b32 v24, v77, 31, v24
    v_lshrrev_b32 v76, 7, v51
    v_lshrrev_b32 v78, 2, v25
    v_mul_u32_u24 v76, 6711, v76
    v_lshrrev_b32 v79, 8, v25
    v_and_b32 v78, 0x3fc, v78
    v_lshrrev_b32 v76, 22, v76
    v_bfi_b32 v79, 15, v25, v79
    v_lshl_or_b32 v78, v76, 10, v78
    v_mad_i32_i24 v51, v76, s44, v51
    ds_add_u32 v78, v8 offset:0
    v_lshl_or_b32 v25, v79, 16, v78
    v_lshrrev_b32 v77, 16, v51
    v_lshl_or_b32 v25, v77, 31, v25
    s_waitcnt vmcnt(0)
    s_mov_b32 s43, 81920
    buffer_load_dwordx4 v[30:33], v1, s[20:23], s43 offen nt
    buffer_load_dwordx4 v[56:59], v1, s[16:19], s43 offen nt
    v_lshrrev_b32 v76, 7, v52
    v_lshrrev_b32 v78, 2, v26
    v_mul_u32_u24 v76, 6711, v76
    v_lshrrev_b32 v79, 8, v26
    v_and_b32 v78, 0x3fc, v78
    v_lshrrev_b32 v76, 22, v76
    v_bfi_b32 v79, 15, v26, v79
    v_lshl_or_b32 v78, v76, 10, v78
    v_mad_i32_i24 v52, v76, s44, v52
    ds_add_u32 v78, v8 offset:0
    v_lshl_or_b32 v26, v79, 16, v78
    v_lshrrev_b32 v77, 16, v52
    v_lshl_or_b32 v26, v77, 31, v26
    v_lshrrev_b32 v76, 7, v53
    v_lshrrev_b32 v78, 2, v27
    v_mul_u32_u24 v76, 6711, v76
    v_lshrrev_b32 v79, 8, v27
    v_and_b32 v78, 0x3fc, v78
    v_lshrrev_b32 v76, 22, v76
    v_bfi_b32 v79, 15, v27, v79
    v_lshl_or_b32 v78, v76, 10, v78
    v_mad_i32_i24 v53, v76, s44, v53
    ds_add_u32 v78, v8 offset:0
    v_lshl_or_b32 v27, v79, 16, v78
    v_lshrrev_b32 v77, 16, v53
    v_lshl_or_b32 v27, v77, 31, v27
    v_lshrrev_b32 v76, 7, v54
    v_lshrrev_b32 v78, 2, v28
    v_mul_u32_u24 v76, 6711, v76
    v_lshrrev_b32 v79, 8, v28
    v_and_b32 v78, 0x3fc, v78
    v_lshrrev_b32 v76, 22, v76
    v_bfi_b32 v79, 15, v28, v79
    v_lshl_or_b32 v78, v76, 10, v78
    v_mad_i32_i24 v54, v76, s44, v54
    ds_add_u32 v78, v8 offset:0
    v_lshl_or_b32 v28, v79, 16, v78
    v_lshrrev_b32 v77, 16, v54
    v_lshl_or_b32 v28, v77, 31, v28
    v_lshrrev_b32 v76, 7, v55
    v_lshrrev_b32 v78, 2, v29
    v_mul_u32_u24 v76, 6711, v76
    v_lshrrev_b32 v79, 8, v29
    v_and_b32 v78, 0x3fc, v78
    v_lshrrev_b32 v76, 22, v76
    v_bfi_b32 v79, 15, v29, v79
    v_lshl_or_b32 v78, v76, 10, v78
    v_mad_i32_i24 v55, v76, s44, v55
    ds_add_u32 v78, v8 offset:0
    v_lshl_or_b32 v29, v79, 16, v78
    v_lshrrev_b32 v77, 16, v55
    v_lshl_or_b32 v29, v77, 31, v29
    s_waitcnt vmcnt(0)
    s_mov_b32 s43, 98304
    buffer_load_dword v34, v3, s[20:23], s43 offen nt
    buffer_load_dword v60, v3, s[16:19], s43 offen nt
    v_lshrrev_b32 v76, 7, v56
    v_lshrrev_b32 v78, 2, v30
    v_mul_u32_u24 v76, 6711, v76
    v_lshrrev_b32 v79, 8, v30
    v_and_b32 v78, 0x3fc, v78
    v_lshrrev_b32 v76, 22, v76
    v_bfi_b32 v79, 15, v30, v79
    v_lshl_or_b32 v78, v76, 10, v78
    v_mad_i32_i24 v56, v76, s44, v56
    ds_add_u32 v78, v8 offset:0
    v_lshl_or_b32 v30, v79, 16, v78
    v_lshrrev_b32 v77, 16, v56
    v_lshl_or_b32 v30, v77, 31, v30
    v_lshrrev_b32 v76, 7, v57
    v_lshrrev_b32 v78, 2, v31
    v_mul_u32_u24 v76, 6711, v76
    v_lshrrev_b32 v79, 8, v31
    v_and_b32 v78, 0x3fc, v78
    v_lshrrev_b32 v76, 22, v76
    v_bfi_b32 v79, 15, v31, v79
    v_lshl_or_b32 v78, v76, 10, v78
    v_mad_i32_i24 v57, v76, s44, v57
    ds_add_u32 v78, v8 offset:0
    v_lshl_or_b32 v31, v79, 16, v78
    v_lshrrev_b32 v77, 16, v57
    v_lshl_or_b32 v31, v77, 31, v31
    v_lshrrev_b32 v76, 7, v58
    v_lshrrev_b32 v78, 2, v32
    v_mul_u32_u24 v76, 6711, v76
    v_lshrrev_b32 v79, 8, v32
    v_and_b32 v78, 0x3fc, v78
    v_lshrrev_b32 v76, 22, v76
    v_bfi_b32 v79, 15, v32, v79
    v_lshl_or_b32 v78, v76, 10, v78
    v_mad_i32_i24 v58, v76, s44, v58
    ds_add_u32 v78, v8 offset:0
    v_lshl_or_b32 v32, v79, 16, v78
    v_lshrrev_b32 v77, 16, v58
    v_lshl_or_b32 v32, v77, 31, v32
    v_lshrrev_b32 v76, 7, v59
    v_lshrrev_b32 v78, 2, v33
    v_mul_u32_u24 v76, 6711, v76
    v_lshrrev_b32 v79, 8, v33
    v_and_b32 v78, 0x3fc, v78
    v_lshrrev_b32 v76, 22, v76
    v_bfi_b32 v79, 15, v33, v79
    v_lshl_or_b32 v78, v76, 10, v78
    v_mad_i32_i24 v59, v76, s44, v59
    ds_add_u32 v78, v8 offset:0
    v_lshl_or_b32 v33, v79, 16, v78
    v_lshrrev_b32 v77, 16, v59
    v_lshl_or_b32 v33, v77, 31, v33
    s_waitcnt vmcnt(0)
    buffer_load_ushort v75, off, s[36:39], 0
    s_mov_b32 s43, 0
    buffer_load_dwordx2 v[62:63], v2, s[24:27], s43 offen nt
    s_mov_b32 s43, 8192
    buffer_load_dwordx2 v[64:65], v2, s[24:27], s43 offen nt
    s_mov_b32 s43, 16384
    buffer_load_dwordx2 v[66:67], v2, s[24:27], s43 offen nt
    s_mov_b32 s43, 24576
    buffer_load_dwordx2 v[68:69], v2, s[24:27], s43 offen nt
    s_mov_b32 s43, 32768
    buffer_load_dwordx2 v[70:71], v2, s[24:27], s43 offen nt
    s_mov_b32 s43, 40960
    buffer_load_dwordx2 v[72:73], v2, s[24:27], s43 offen nt
    s_mov_b32 s43, 49152
    buffer_load_ushort v74, v4, s[24:27], s43 offen nt
    s_mov_b64 s[50:51], exec
    s_and_b64 exec, exec, s[48:49]
    s_cbranch_execz K1_notail1
    v_lshrrev_b32 v76, 7, v60
    v_lshrrev_b32 v78, 2, v34
    v_mul_u32_u24 v76, 6711, v76
    v_lshrrev_b32 v79, 8, v34
    v_and_b32 v78, 0x3fc, v78
    v_lshrrev_b32 v76, 22, v76
    v_bfi_b32 v79, 15, v34, v79
    v_lshl_or_b32 v78, v76, 10, v78
    v_mad_i32_i24 v60, v76, s44, v60
    ds_add_u32 v78, v8 offset:0
    v_lshl_or_b32 v34, v79, 16, v78
    v_lshrrev_b32 v77, 16, v60
    v_lshl_or_b32 v34, v77, 31, v34
K1_notail1:
    s_mov_b64 exec, s[50:51]
    s_waitcnt lgkmcnt(0)
    s_barrier
    ds_read_b64 v[76:77], v2 offset:0
    s_waitcnt lgkmcnt(0)
    v_add_u32 v78, v76, v77
    v_mov_b32 v79, v78
    s_nop 1
    v_add_u32_dpp v79, v79, v79 row_shr:1 row_mask:0xf bank_mask:0xf bound_ctrl:1
    s_nop 1
    v_add_u32_dpp v79, v79, v79 row_shr:2 row_mask:0xf bank_mask:0xf bound_ctrl:1
    s_nop 1
    v_add_u32_dpp v79, v79, v79 row_shr:4 row_mask:0xf bank_mask:0xf bound_ctrl:1
    s_nop 1
    v_add_u32_dpp v79, v79, v79 row_shr:8 row_mask:0xf bank_mask:0xf bound_ctrl:1
    s_nop 1
    v_add_u32_dpp v79, v79, v79 row_bcast:15 row_mask:0xa bank_mask:0xf
    s_nop 1
    v_add_u32_dpp v79, v79, v79 row_bcast:31 row_mask:0xc bank_mask:0xf
    s_nop 1
    v_readlane_b32 s52, v79, 63
    s_lshl_b32 s53, s3, 2
    v_mov_b32 v81, s53
    s_nop 0
    v_mov_b32 v80, s52
    ds_write_b32 v81, v80 offset:8192
    s_waitcnt lgkmcnt(0)
    s_barrier
    v_and_b32 v80, 15, v0
    v_lshlrev_b32 v80, 2, v80
    ds_read_b32 v81, v80 offset:8192
    s_waitcnt lgkmcnt(0)
    s_nop 1
    v_add_u32_dpp v81, v81, v81 row_shr:1 row_mask:0xf bank_mask:0xf bound_ctrl:1
    s_nop 1
    v_add_u32_dpp v81, v81, v81 row_shr:2 row_mask:0xf bank_mask:0xf bound_ctrl:1
    s_nop 1
    v_add_u32_dpp v81, v81, v81 row_shr:4 row_mask:0xf bank_mask:0xf bound_ctrl:1
    s_nop 1
    v_add_u32_dpp v81, v81, v81 row_shr:8 row_mask:0xf bank_mask:0xf bound_ctrl:1
    s_add_u32 s53, s3, 15
    s_and_b32 s53, s53, 15
    s_nop 3
    v_readlane_b32 s52, v81, s53
    s_cmp_eq_u32 s3, 0
    s_nop 3
    s_cselect_b32 s52, 0, s52
    v_sub_u32 v82, v79, v78
    v_add_u32 v82, s52, v82
    v_add_u32 v83, v82, v76
    ds_write_b64 v2, v[82:83] offset:0
    v_lshl_or_b32 v84, v76, 16, v82
    v_lshl_or_b32 v85, v77, 16, v83
    ds_write_b64 v2, v[84:85] offset:8320

    s_waitcnt lgkmcnt(0)
    s_barrier
    v_lshrrev_b32 v86, 2, v0
    v_and_b32 v87, 3, v0
    v_lshlrev_b32 v86, 2, v86
    v_lshl_add_u32 v86, v87, 11, v86
    ds_read_b32 v84, v86 offset:8320
    ds_read_b32 v85, v86 offset:9344
    s_waitcnt lgkmcnt(0)
    s_barrier
    s_mov_b32 s54, 0xffff
    s_mov_b32 s55, 0xffff0000
    s_mov_b32 s60, 0x3e22f983
    s_mov_b32 s62, 0x05040100
    s_mov_b32 s63, 0x07060100
    s_waitcnt vmcnt(0)
    s_lshl_b32 s43, s2, 13
    buffer_store_dwordx2 v[84:85], v2, s[32:35], s43 offen
    s_mov_b32 s56, s12
    s_mov_b32 s57, s13
    s_mov_b32 s58, 12800000
    s_mov_b32 s59, 0x20000
    s_mul_i32 s43, s2, 50048
    v_lshlrev_b32 v88, 7, v0
    s_cmp_ge_u32 s3, 7
    s_cbranch_scc1 K1_nopf
    v_mov_b32 v90, 0x7fff0000
    s_movk_i32 s47, 391
    v_cmp_gt_u32 vcc, s47, v0
    s_nop 1
    v_cndmask_b32 v88, v90, v88, vcc
    buffer_load_dword v89, v88, s[56:59], s43 offen
K1_nopf:
    v_lshlrev_b32 v75, 16, v75
    v_and_b32 v91, s54, v10
    v_and_b32 v92, s54, v11
    v_and_b32 v93, s54, v12
    v_and_b32 v94, s54, v13
    v_and_b32 v95, s54, v14
    v_and_b32 v96, s54, v15
    v_and_b32 v97, s54, v16
    v_and_b32 v98, s54, v17
    ds_add_rtn_u32 v91, v91, v8 offset:0
    ds_add_rtn_u32 v92, v92, v8 offset:0
    ds_add_rtn_u32 v93, v93, v8 offset:0
    ds_add_rtn_u32 v94, v94, v8 offset:0
    ds_add_rtn_u32 v95, v95, v8 offset:0
    ds_add_rtn_u32 v96, v96, v8 offset:0
    ds_add_rtn_u32 v97, v97, v8 offset:0
    ds_add_rtn_u32 v98, v98, v8 offset:0
    v_lshlrev_b32 v76, 16, v62
    v_and_b32 v77, s55, v62
    v_mul_f32 v76, v75, v76
    v_mul_f32 v77, v75, v77
    v_cvt_pk_bf16_f32 v78, v76, v77
    v_lshlrev_b32 v76, 16, v78
    v_and_b32 v77, s55, v78
    v_mul_f32 v76, s60, v76
    v_mul_f32 v77, s60, v77
    v_fract_f32 v76, v76
    v_fract_f32 v77, v77
    v_cos_f32 v76, v76
    v_cos_f32 v77, v77
    s_nop 0
    v_cvt_pk_bf16_f32 v78, v76, v77
    v_perm_b32 v36, v78, v36, s62
    v_perm_b32 v37, v78, v37, s63
    v_lshlrev_b32 v76, 16, v63
    v_and_b32 v77, s55, v63
    v_mul_f32 v76, v75, v76
    v_mul_f32 v77, v75, v77
    v_cvt_pk_bf16_f32 v78, v76, v77
    v_lshlrev_b32 v76, 16, v78
    v_and_b32 v77, s55, v78
    v_mul_f32 v76, s60, v76
    v_mul_f32 v77, s60, v77
    v_fract_f32 v76, v76
    v_fract_f32 v77, v77
    v_cos_f32 v76, v76
    v_cos_f32 v77, v77
    s_nop 0
    v_cvt_pk_bf16_f32 v78, v76, v77
    v_perm_b32 v38, v78, v38, s62
    v_perm_b32 v39, v78, v39, s63
    v_lshlrev_b32 v76, 16, v64
    v_and_b32 v77, s55, v64
    v_mul_f32 v76, v75, v76
    v_mul_f32 v77, v75, v77
    v_cvt_pk_bf16_f32 v78, v76, v77
    v_lshlrev_b32 v76, 16, v78
    v_and_b32 v77, s55, v78
    v_mul_f32 v76, s60, v76
    v_mul_f32 v77, s60, v77
    v_fract_f32 v76, v76
    v_fract_f32 v77, v77
    v_cos_f32 v76, v76
    v_cos_f32 v77, v77
    s_nop 0
    v_cvt_pk_bf16_f32 v78, v76, v77
    v_perm_b32 v40, v78, v40, s62
    v_perm_b32 v41, v78, v41, s63
    v_lshlrev_b32 v76, 16, v65
    v_and_b32 v77, s55, v65
    v_mul_f32 v76, v75, v76
    v_mul_f32 v77, v75, v77
    v_cvt_pk_bf16_f32 v78, v76, v77
    v_lshlrev_b32 v76, 16, v78
    v_and_b32 v77, s55, v78
    v_mul_f32 v76, s60, v76
    v_mul_f32 v77, s60, v77
    v_fract_f32 v76, v76
    v_fract_f32 v77, v77
    v_cos_f32 v76, v76
    v_cos_f32 v77, v77
    s_nop 0
    v_cvt_pk_bf16_f32 v78, v76, v77
    v_perm_b32 v42, v78, v42, s62
    v_perm_b32 v43, v78, v43, s63
    s_waitcnt lgkmcnt(7)
    v_mul_u32_u24 v80, 6, v91
    v_and_b32 v81, 1, v91
    v_lshl_add_u32 v82, v81, 1, v80
    v_mad_i32_i24 v83, v81, -4, v80
    ds_write_b32 v82, v36 offset:8320
    ds_write_b16_d16_hi v83, v10 offset:8324
    s_waitcnt lgkmcnt(8)
    v_mul_u32_u24 v80, 6, v92
    v_and_b32 v81, 1, v92
    v_lshl_add_u32 v82, v81, 1, v80
    v_mad_i32_i24 v83, v81, -4, v80
    ds_write_b32 v82, v37 offset:8320
    ds_write_b16_d16_hi v83, v11 offset:8324
    s_waitcnt lgkmcnt(9)
    v_mul_u32_u24 v80, 6, v93
    v_and_b32 v81, 1, v93
    v_lshl_add_u32 v82, v81, 1, v80
    v_mad_i32_i24 v83, v81, -4, v80
    ds_write_b32 v82, v38 offset:8320
    ds_write_b16_d16_hi v83, v12 offset:8324
    s_waitcnt lgkmcnt(10)
    v_mul_u32_u24 v80, 6, v94
    v_and_b32 v81, 1, v94
    v_lshl_add_u32 v82, v81, 1, v80
    v_mad_i32_i24 v83, v81, -4, v80
    ds_write_b32 v82, v39 offset:8320
    ds_write_b16_d16_hi v83, v13 offset:8324
    s_waitcnt lgkmcnt(11)
    v_mul_u32_u24 v80, 6, v95
    v_and_b32 v81, 1, v95
    v_lshl_add_u32 v82, v81, 1, v80
    v_mad_i32_i24 v83, v81, -4, v80
    ds_write_b32 v82, v40 offset:8320
    ds_write_b16_d16_hi v83, v14 offset:8324
    s_waitcnt lgkmcnt(12)
    v_mul_u32_u24 v80, 6, v96
    v_and_b32 v81, 1, v96
    v_lshl_add_u32 v82, v81, 1, v80
    v_mad_i32_i24 v83, v81, -4, v80
    ds_write_b32 v82, v41 offset:8320
    ds_write_b16_d16_hi v83, v15 offset:8324
    s_waitcnt lgkmcnt(13)
    v_mul_u32_u24 v80, 6, v97
    v_and_b32 v81, 1, v97
    v_lshl_add_u32 v82, v81, 1, v80
    v_mad_i32_i24 v83, v81, -4, v80
    ds_write_b32 v82, v42 offset:8320
    ds_write_b16_d16_hi v83, v16 offset:8324
    s_waitcnt lgkmcnt(14)
    v_mul_u32_u24 v80, 6, v98
    v_and_b32 v81, 1, v98
    v_lshl_add_u32 v82, v81, 1, v80
    v_mad_i32_i24 v83, v81, -4, v80
    ds_write_b32 v82, v43 offset:8320
    ds_write_b16_d16_hi v83, v17 offset:8324
    v_and_b32 v91, s54, v18
    v_and_b32 v92, s54, v19
    v_and_b32 v93, s54, v20
    v_and_b32 v94, s54, v21
    v_and_b32 v95, s54, v22
    v_and_b32 v96, s54, v23
    v_and_b32 v97, s54, v24
    v_and_b32 v98, s54, v25
    ds_add_rtn_u32 v91, v91, v8 offset:0
    ds_add_rtn_u32 v92, v92, v8 offset:0
    ds_add_rtn_u32 v93, v93, v8 offset:0
    ds_add_rtn_u32 v94, v94, v8 offset:0
    ds_add_rtn_u32 v95, v95, v8 offset:0
    ds_add_rtn_u32 v96, v96, v8 offset:0
    ds_add_rtn_u32 v97, v97, v8 offset:0
    ds_add_rtn_u32 v98, v98, v8 offset:0
    v_lshlrev_b32 v76, 16, v66
    v_and_b32 v77, s55, v66
    v_mul_f32 v76, v75, v76
    v_mul_f32 v77, v75, v77
    v_cvt_pk_bf16_f32 v78, v76, v77
    v_lshlrev_b32 v76, 16, v78
    v_and_b32 v77, s55, v78
    v_mul_f32 v76, s60, v76
    v_mul_f32 v77, s60, v77
    v_fract_f32 v76, v76
    v_fract_f32 v77, v77
    v_cos_f32 v76, v76
    v_cos_f32 v77, v77
    s_nop 0
    v_cvt_pk_bf16_f32 v78, v76, v77
    v_perm_b32 v44, v78, v44, s62
    v_perm_b32 v45, v78, v45, s63
    v_lshlrev_b32 v76, 16, v67
    v_and_b32 v77, s55, v67
    v_mul_f32 v76, v75, v76
    v_mul_f32 v77, v75, v77
    v_cvt_pk_bf16_f32 v78, v76, v77
    v_lshlrev_b32 v76, 16, v78
    v_and_b32 v77, s55, v78
    v_mul_f32 v76, s60, v76
    v_mul_f32 v77, s60, v77
    v_fract_f32 v76, v76
    v_fract_f32 v77, v77
    v_cos_f32 v76, v76
    v_cos_f32 v77, v77
    s_nop 0
    v_cvt_pk_bf16_f32 v78, v76, v77
    v_perm_b32 v46, v78, v46, s62
    v_perm_b32 v47, v78, v47, s63
    v_lshlrev_b32 v76, 16, v68
    v_and_b32 v77, s55, v68
    v_mul_f32 v76, v75, v76
    v_mul_f32 v77, v75, v77
    v_cvt_pk_bf16_f32 v78, v76, v77
    v_lshlrev_b32 v76, 16, v78
    v_and_b32 v77, s55, v78
    v_mul_f32 v76, s60, v76
    v_mul_f32 v77, s60, v77
    v_fract_f32 v76, v76
    v_fract_f32 v77, v77
    v_cos_f32 v76, v76
    v_cos_f32 v77, v77
    s_nop 0
    v_cvt_pk_bf16_f32 v78, v76, v77
    v_perm_b32 v48, v78, v48, s62
    v_perm_b32 v49, v78, v49, s63
    v_lshlrev_b32 v76, 16, v69
    v_and_b32 v77, s55, v69
    v_mul_f32 v76, v75, v76
    v_mul_f32 v77, v75, v77
    v_cvt_pk_bf16_f32 v78, v76, v77
    v_lshlrev_b32 v76, 16, v78
    v_and_b32 v77, s55, v78
    v_mul_f32 v76, s60, v76
    v_mul_f32 v77, s60, v77
    v_fract_f32 v76, v76
    v_fract_f32 v77, v77
    v_cos_f32 v76, v76
    v_cos_f32 v77, v77
    s_nop 0
    v_cvt_pk_bf16_f32 v78, v76, v77
    v_perm_b32 v50, v78, v50, s62
    v_perm_b32 v51, v78, v51, s63
    s_waitcnt lgkmcnt(7)
    v_mul_u32_u24 v80, 6, v91
    v_and_b32 v81, 1, v91
    v_lshl_add_u32 v82, v81, 1, v80
    v_mad_i32_i24 v83, v81, -4, v80
    ds_write_b32 v82, v44 offset:8320
    ds_write_b16_d16_hi v83, v18 offset:8324
    s_waitcnt lgkmcnt(8)
    v_mul_u32_u24 v80, 6, v92
    v_and_b32 v81, 1, v92
    v_lshl_add_u32 v82, v81, 1, v80
    v_mad_i32_i24 v83, v81, -4, v80
    ds_write_b32 v82, v45 offset:8320
    ds_write_b16_d16_hi v83, v19 offset:8324
    s_waitcnt lgkmcnt(9)
    v_mul_u32_u24 v80, 6, v93
    v_and_b32 v81, 1, v93
    v_lshl_add_u32 v82, v81, 1, v80
    v_mad_i32_i24 v83, v81, -4, v80
    ds_write_b32 v82, v46 offset:8320
    ds_write_b16_d16_hi v83, v20 offset:8324
    s_waitcnt lgkmcnt(10)
    v_mul_u32_u24 v80, 6, v94
    v_and_b32 v81, 1, v94
    v_lshl_add_u32 v82, v81, 1, v80
    v_mad_i32_i24 v83, v81, -4, v80
    ds_write_b32 v82, v47 offset:8320
    ds_write_b16_d16_hi v83, v21 offset:8324
    s_waitcnt lgkmcnt(11)
    v_mul_u32_u24 v80, 6, v95
    v_and_b32 v81, 1, v95
    v_lshl_add_u32 v82, v81, 1, v80
    v_mad_i32_i24 v83, v81, -4, v80
    ds_write_b32 v82, v48 offset:8320
    ds_write_b16_d16_hi v83, v22 offset:8324
    s_waitcnt lgkmcnt(12)
    v_mul_u32_u24 v80, 6, v96
    v_and_b32 v81, 1, v96
    v_lshl_add_u32 v82, v81, 1, v80
    v_mad_i32_i24 v83, v81, -4, v80
    ds_write_b32 v82, v49 offset:8320
    ds_write_b16_d16_hi v83, v23 offset:8324
    s_waitcnt lgkmcnt(13)
    v_mul_u32_u24 v80, 6, v97
    v_and_b32 v81, 1, v97
    v_lshl_add_u32 v82, v81, 1, v80
    v_mad_i32_i24 v83, v81, -4, v80
    ds_write_b32 v82, v50 offset:8320
    ds_write_b16_d16_hi v83, v24 offset:8324
    s_waitcnt lgkmcnt(14)
    v_mul_u32_u24 v80, 6, v98
    v_and_b32 v81, 1, v98
    v_lshl_add_u32 v82, v81, 1, v80
    v_mad_i32_i24 v83, v81, -4, v80
    ds_write_b32 v82, v51 offset:8320
    ds_write_b16_d16_hi v83, v25 offset:8324
    v_and_b32 v91, s54, v26
    v_and_b32 v92, s54, v27
    v_and_b32 v93, s54, v28
    v_and_b32 v94, s54, v29
    v_and_b32 v95, s54, v30
    v_and_b32 v96, s54, v31
    v_and_b32 v97, s54, v32
    v_and_b32 v98, s54, v33
    ds_add_rtn_u32 v91, v91, v8 offset:0
    ds_add_rtn_u32 v92, v92, v8 offset:0
    ds_add_rtn_u32 v93, v93, v8 offset:0
    ds_add_rtn_u32 v94, v94, v8 offset:0
    ds_add_rtn_u32 v95, v95, v8 offset:0
    ds_add_rtn_u32 v96, v96, v8 offset:0
    ds_add_rtn_u32 v97, v97, v8 offset:0
    ds_add_rtn_u32 v98, v98, v8 offset:0
    v_lshlrev_b32 v76, 16, v70
    v_and_b32 v77, s55, v70
    v_mul_f32 v76, v75, v76
    v_mul_f32 v77, v75, v77
    v_cvt_pk_bf16_f32 v78, v76, v77
    v_lshlrev_b32 v76, 16, v78
    v_and_b32 v77, s55, v78
    v_mul_f32 v76, s60, v76
    v_mul_f32 v77, s60, v77
    v_fract_f32 v76, v76
    v_fract_f32 v77, v77
    v_cos_f32 v76, v76
    v_cos_f32 v77, v77
    s_nop 0
    v_cvt_pk_bf16_f32 v78, v76, v77
    v_perm_b32 v52, v78, v52, s62
    v_perm_b32 v53, v78, v53, s63
    v_lshlrev_b32 v76, 16, v71
    v_and_b32 v77, s55, v71
    v_mul_f32 v76, v75, v76
    v_mul_f32 v77, v75, v77
    v_cvt_pk_bf16_f32 v78, v76, v77
    v_lshlrev_b32 v76, 16, v78
    v_and_b32 v77, s55, v78
    v_mul_f32 v76, s60, v76
    v_mul_f32 v77, s60, v77
    v_fract_f32 v76, v76
    v_fract_f32 v77, v77
    v_cos_f32 v76, v76
    v_cos_f32 v77, v77
    s_nop 0
    v_cvt_pk_bf16_f32 v78, v76, v77
    v_perm_b32 v54, v78, v54, s62
    v_perm_b32 v55, v78, v55, s63
    v_lshlrev_b32 v76, 16, v72
    v_and_b32 v77, s55, v72
    v_mul_f32 v76, v75, v76
    v_mul_f32 v77, v75, v77
    v_cvt_pk_bf16_f32 v78, v76, v77
    v_lshlrev_b32 v76, 16, v78
    v_and_b32 v77, s55, v78
    v_mul_f32 v76, s60, v76
    v_mul_f32 v77, s60, v77
    v_fract_f32 v76, v76
    v_fract_f32 v77, v77
    v_cos_f32 v76, v76
    v_cos_f32 v77, v77
    s_nop 0
    v_cvt_pk_bf16_f32 v78, v76, v77
    v_perm_b32 v56, v78, v56, s62
    v_perm_b32 v57, v78, v57, s63
    v_lshlrev_b32 v76, 16, v73
    v_and_b32 v77, s55, v73
    v_mul_f32 v76, v75, v76
    v_mul_f32 v77, v75, v77
    v_cvt_pk_bf16_f32 v78, v76, v77
    v_lshlrev_b32 v76, 16, v78
    v_and_b32 v77, s55, v78
    v_mul_f32 v76, s60, v76
    v_mul_f32 v77, s60, v77
    v_fract_f32 v76, v76
    v_fract_f32 v77, v77
    v_cos_f32 v76, v76
    v_cos_f32 v77, v77
    s_nop 0
    v_cvt_pk_bf16_f32 v78, v76, v77
    v_perm_b32 v58, v78, v58, s62
    v_perm_b32 v59, v78, v59, s63
    s_waitcnt lgkmcnt(7)
    v_mul_u32_u24 v80, 6, v91
    v_and_b32 v81, 1, v91
    v_lshl_add_u32 v82, v81, 1, v80
    v_mad_i32_i24 v83, v81, -4, v80
    ds_write_b32 v82, v52 offset:8320
    ds_write_b16_d16_hi v83, v26 offset:8324
    s_waitcnt lgkmcnt(8)
    v_mul_u32_u24 v80, 6, v92
    v_and_b32 v81, 1, v92
    v_lshl_add_u32 v82, v81, 1, v80
    v_mad_i32_i24 v83, v81, -4, v80
    ds_write_b32 v82, v53 offset:8320
    ds_write_b16_d16_hi v83, v27 offset:8324
    s_waitcnt lgkmcnt(9)
    v_mul_u32_u24 v80, 6, v93
    v_and_b32 v81, 1, v93
    v_lshl_add_u32 v82, v81, 1, v80
    v_mad_i32_i24 v83, v81, -4, v80
    ds_write_b32 v82, v54 offset:8320
    ds_write_b16_d16_hi v83, v28 offset:8324
    s_waitcnt lgkmcnt(10)
    v_mul_u32_u24 v80, 6, v94
    v_and_b32 v81, 1, v94
    v_lshl_add_u32 v82, v81, 1, v80
    v_mad_i32_i24 v83, v81, -4, v80
    ds_write_b32 v82, v55 offset:8320
    ds_write_b16_d16_hi v83, v29 offset:8324
    s_waitcnt lgkmcnt(11)
    v_mul_u32_u24 v80, 6, v95
    v_and_b32 v81, 1, v95
    v_lshl_add_u32 v82, v81, 1, v80
    v_mad_i32_i24 v83, v81, -4, v80
    ds_write_b32 v82, v56 offset:8320
    ds_write_b16_d16_hi v83, v30 offset:8324
    s_waitcnt lgkmcnt(12)
    v_mul_u32_u24 v80, 6, v96
    v_and_b32 v81, 1, v96
    v_lshl_add_u32 v82, v81, 1, v80
    v_mad_i32_i24 v83, v81, -4, v80
    ds_write_b32 v82, v57 offset:8320
    ds_write_b16_d16_hi v83, v31 offset:8324
    s_waitcnt lgkmcnt(13)
    v_mul_u32_u24 v80, 6, v97
    v_and_b32 v81, 1, v97
    v_lshl_add_u32 v82, v81, 1, v80
    v_mad_i32_i24 v83, v81, -4, v80
    ds_write_b32 v82, v58 offset:8320
    ds_write_b16_d16_hi v83, v32 offset:8324
    s_waitcnt lgkmcnt(14)
    v_mul_u32_u24 v80, 6, v98
    v_and_b32 v81, 1, v98
    v_lshl_add_u32 v82, v81, 1, v80
    v_mad_i32_i24 v83, v81, -4, v80
    ds_write_b32 v82, v59 offset:8320
    ds_write_b16_d16_hi v83, v33 offset:8324
    s_mov_b64 s[50:51], exec
    s_and_b64 exec, exec, s[48:49]
    s_cbranch_execz K1_notail2
    v_and_b32 v91, s54, v34
    ds_add_rtn_u32 v91, v91, v8 offset:0
    v_lshlrev_b32 v76, 16, v74
    v_and_b32 v77, s55, v74
    v_mul_f32 v76, v75, v76
    v_mul_f32 v77, v75, v77
    v_cvt_pk_bf16_f32 v78, v76, v77
    v_lshlrev_b32 v76, 16, v78
    v_and_b32 v77, s55, v78
    v_mul_f32 v76, s60, v76
    v_mul_f32 v77, s60, v77
    v_fract_f32 v76, v76
    v_fract_f32 v77, v77
    v_cos_f32 v76, v76
    v_cos_f32 v77, v77
    s_nop 0
    v_cvt_pk_bf16_f32 v78, v76, v77
    v_perm_b32 v60, v78, v60, s62
    s_waitcnt lgkmcnt(0)
    v_mul_u32_u24 v80, 6, v91
    v_and_b32 v81, 1, v91
    v_lshl_add_u32 v82, v81, 1, v80
    v_mad_i32_i24 v83, v81, -4, v80
    ds_write_b32 v82, v60 offset:8320
    ds_write_b16_d16_hi v83, v34 offset:8324
K1_notail2:
    s_mov_b64 exec, s[50:51]
    s_waitcnt lgkmcnt(0)
    s_barrier
    ds_read_b128 v[10:13], v1 offset:8320
    ds_read_b128 v[14:17], v1 offset:24704
    ds_read_b128 v[18:21], v1 offset:41088
    ds_read_b128 v[22:25], v1 offset:57472
    v_add_u32 v76, 73856, v1
    ds_read_b128 v[26:29], v76
    v_add_u32 v76, 90240, v1
    ds_read_b128 v[30:33], v76
    v_add_u32 v76, 106624, v1
    ds_read_b128 v[34:37], v76
    v_add_u32 v76, 123008, v1
    ds_read_b128 v[38:41], v76
    v_add_u32 v76, 139392, v1
    ds_read_b128 v[42:45], v76
    v_add_u32 v76, 155776, v1
    ds_read_b128 v[46:49], v76
    s_waitcnt lgkmcnt(9)
    s_mov_b32 s43, 0
    buffer_store_dwordx4 v[10:13], v1, s[28:31], s43 offen sc1
    s_waitcnt lgkmcnt(8)
    s_mov_b32 s43, 16384
    buffer_store_dwordx4 v[14:17], v1, s[28:31], s43 offen sc1
    s_waitcnt lgkmcnt(7)
    s_mov_b32 s43, 32768
    buffer_store_dwordx4 v[18:21], v1, s[28:31], s43 offen sc1
    s_waitcnt lgkmcnt(6)
    s_mov_b32 s43, 49152
    buffer_store_dwordx4 v[22:25], v1, s[28:31], s43 offen sc1
    s_waitcnt lgkmcnt(5)
    s_mov_b32 s43, 65536
    buffer_store_dwordx4 v[26:29], v1, s[28:31], s43 offen sc1
    s_waitcnt lgkmcnt(4)
    s_mov_b32 s43, 81920
    buffer_store_dwordx4 v[30:33], v1, s[28:31], s43 offen sc1
    s_waitcnt lgkmcnt(3)
    s_mov_b32 s43, 98304
    buffer_store_dwordx4 v[34:37], v1, s[28:31], s43 offen sc1
    s_waitcnt lgkmcnt(2)
    s_mov_b32 s43, 114688
    buffer_store_dwordx4 v[38:41], v1, s[28:31], s43 offen sc1
    s_waitcnt lgkmcnt(1)
    s_mov_b32 s43, 131072
    buffer_store_dwordx4 v[42:45], v1, s[28:31], s43 offen sc1
    s_waitcnt lgkmcnt(0)
    s_mov_b32 s43, 147456
    buffer_store_dwordx4 v[46:49], v1, s[28:31], s43 offen sc1
K1_end:
    s_endpgm
.globl gem_gath_kernel
.p2align 8
.type gem_gath_kernel,@function
gem_gath_kernel:
    s_cmp_ge_u32 s2, 256
    s_cbranch_scc1 K2_end
    s_load_dwordx2 s[4:5], s[0:1], 0
    s_load_dwordx2 s[6:7], s[0:1], 104
    s_load_dwordx2 s[22:23], s[0:1], 72
    v_lshrrev_b32 v2, 6, v0
    v_and_b32 v1, 63, v0
    s_nop 0
    v_readfirstlane_b32 s3, v2
    s_waitcnt lgkmcnt(0)
    s_cmp_ge_u32 s3, 7
    s_cbranch_scc1 K2_producer
    s_setprio 1
    s_cmp_lt_u32 s3, 4
    s_cbranch_scc1 K2_cprio
    s_setprio 1
K2_cprio:
    s_mov_b32 s44, s22
    s_mov_b32 s45, s23
    s_mov_b32 s46, 512
    s_mov_b32 s47, 0x20000
    v_and_b32 v20, 15, v1
    v_lshrrev_b32 v21, 4, v1
    v_and_b32 v11, 1, v21
    v_lshlrev_b32 v10, 8, v11
    v_lshl_add_u32 v10, v20, 1, v10
    buffer_load_ushort v32, v10, s[44:47], 0 offen offset:0
    buffer_load_ushort v33, v10, s[44:47], 0 offen offset:32
    buffer_load_ushort v34, v10, s[44:47], 0 offen offset:64
    buffer_load_ushort v35, v10, s[44:47], 0 offen offset:96
    buffer_load_ushort v36, v10, s[44:47], 0 offen offset:128
    buffer_load_ushort v37, v10, s[44:47], 0 offen offset:160
    buffer_load_ushort v38, v10, s[44:47], 0 offen offset:192
    buffer_load_ushort v39, v10, s[44:47], 0 offen offset:224
    v_lshlrev_b32 v11, 4, v11
    v_mov_b32 v13, v11
    v_mov_b32 v15, v11
    v_mov_b32 v17, v11
    v_sub_u32 v5, 15, v20
    s_mov_b32 s57, 0x000f000f
    s_mul_i32 s48, s3, 10976
    s_add_u32 s48, s48, 1088
    v_lshrrev_b32 v2, 1, v21
    v_lshlrev_b32 v2, 2, v2
    v_lshl_add_u32 v2, v20, 3, v2
    v_add_u32 v2, s48, v2
    v_lshlrev_b32 v3, 4, v21
    v_add_u32 v3, s48, v3
    v_lshlrev_b32 v4, 3, v1
    v_min_u32 v12, 47, v1
    v_lshlrev_b32 v12, 3, v12
    v_add_u32 v12, 320, v12
    v_cmp_gt_u32 vcc, 32, v1
    v_mov_b32 v8, 0
    v_mov_b32 v14, -1
    v_cndmask_b32 v4, v12, v4, vcc
    v_cndmask_b32 v8, v8, v14, vcc
    v_add_u32 v4, s48, v4
    v_mov_b32 v9, v8
    s_mul_i32 s49, s3, 56
    v_lshl_add_u32 v6, v1, 2, s49
    v_mov_b32 v12, 0
    v_lshlrev_b32 v14, 2, v0
    s_movk_i32 s49, 272
    v_cmp_gt_u32 vcc, s49, v0
    s_and_saveexec_b64 s[50:51], vcc
    ds_write_b32 v14, v12
    s_mov_b64 exec, s[50:51]
    ds_write_b64 v4, v[8:9] offset:0
    ds_write_b64 v4, v[8:9] offset:784
    ds_write_b64 v4, v[8:9] offset:1568
    ds_write_b64 v4, v[8:9] offset:2352
    ds_write_b64 v4, v[8:9] offset:3136
    ds_write_b64 v4, v[8:9] offset:3920
    ds_write_b64 v4, v[8:9] offset:4704
    ds_write_b64 v4, v[8:9] offset:5488
    ds_write_b64 v4, v[8:9] offset:6272
    ds_write_b64 v4, v[8:9] offset:7056
    ds_write_b64 v4, v[8:9] offset:7840
    ds_write_b64 v4, v[8:9] offset:8624
    ds_write_b64 v4, v[8:9] offset:9408
    ds_write_b64 v4, v[8:9] offset:10192
    v_add_u32 v14, 76832, v4
    ds_write_b64 v14, v[8:9] offset:0
    ds_write_b64 v14, v[8:9] offset:784
    ds_write_b64 v14, v[8:9] offset:1568
    ds_write_b64 v14, v[8:9] offset:2352
    ds_write_b64 v14, v[8:9] offset:3136
    ds_write_b64 v14, v[8:9] offset:3920
    ds_write_b64 v14, v[8:9] offset:4704
    ds_write_b64 v14, v[8:9] offset:5488
    ds_write_b64 v14, v[8:9] offset:6272
    ds_write_b64 v14, v[8:9] offset:7056
    ds_write_b64 v14, v[8:9] offset:7840
    ds_write_b64 v14, v[8:9] offset:8624
    ds_write_b64 v14, v[8:9] offset:9408
    ds_write_b64 v14, v[8:9] offset:10192
    s_waitcnt lgkmcnt(0)
    s_barrier
    v_mov_b32 v72, 0
    v_mov_b32 v73, 0
    v_mov_b32 v74, 0
    v_mov_b32 v75, 0
    v_mov_b32 v76, 0
    v_mov_b32 v77, 0
    v_mov_b32 v78, 0
    v_mov_b32 v79, 0
    v_mov_b32 v80, 0
    v_mov_b32 v81, 0
    v_mov_b32 v82, 0
    v_mov_b32 v83, 0
    v_mov_b32 v84, 0
    v_mov_b32 v85, 0
    v_mov_b32 v86, 0
    v_mov_b32 v87, 0
    v_mov_b32 v88, 0
    v_mov_b32 v89, 0
    v_mov_b32 v90, 0
    v_mov_b32 v91, 0
    v_mov_b32 v92, 0
    v_mov_b32 v93, 0
    v_mov_b32 v94, 0
    v_mov_b32 v95, 0
    v_mov_b32 v96, 0
    v_mov_b32 v97, 0
    v_mov_b32 v98, 0
    v_mov_b32 v99, 0
    v_mov_b32 v100, 0
    v_mov_b32 v101, 0
    v_mov_b32 v102, 0
    v_mov_b32 v103, 0
    v_mov_b32 v104, 0
    v_mov_b32 v105, 0
    v_mov_b32 v106, 0
    v_mov_b32 v107, 0
    v_mov_b32 v108, 0
    v_mov_b32 v109, 0
    v_mov_b32 v110, 0
    v_mov_b32 v111, 0
    v_mov_b32 v112, 0
    v_mov_b32 v113, 0
    v_mov_b32 v114, 0
    v_mov_b32 v115, 0
    v_mov_b32 v116, 0
    v_mov_b32 v117, 0
    v_mov_b32 v118, 0
    v_mov_b32 v119, 0
    v_mov_b32 v120, 0
    v_mov_b32 v121, 0
    v_mov_b32 v122, 0
    v_mov_b32 v123, 0
    v_mov_b32 v124, 0
    v_mov_b32 v125, 0
    v_mov_b32 v126, 0
    v_mov_b32 v127, 0
    s_waitcnt vmcnt(0)
    v_cmp_gt_u32 vcc, 32, v1
    v_lshl_or_b32 v32, v33, 16, v32
    v_lshl_or_b32 v34, v35, 16, v34
    v_lshl_or_b32 v36, v37, 16, v36
    v_lshl_or_b32 v38, v39, 16, v38
    v_cndmask_b32 v24, 0, v32, vcc
    v_cndmask_b32 v25, 0, v34, vcc
    v_cndmask_b32 v26, 0, v36, vcc
    v_cndmask_b32 v27, 0, v38, vcc
    s_not_b64 vcc, vcc
    v_cndmask_b32 v28, 0, v32, vcc
    v_cndmask_b32 v29, 0, v34, vcc
    v_cndmask_b32 v30, 0, v36, vcc
    v_cndmask_b32 v31, 0, v38, vcc
    s_mov_b32 s8, s4
    s_or_b32 s9, s5, 2097152
    s_mov_b32 s10, 80000
    s_mov_b32 s11, 0x20000
    s_add_u32 s12, s8, 2560000
    s_addc_u32 s13, s9, 0
    s_mov_b32 s14, 80000
    s_mov_b32 s15, 0x20000
    v_mov_b32 v19, v11
    v_add_u32 v7, 76832, v2
    v_add_u32 v0, 76832, v3
    s_mov_b32 s55, 76832
    s_movk_i32 s56, 512
    s_mul_i32 s70, s3, 10976
    s_add_u32 s70, s70, 1088
    s_mov_b32 s67, -1
    s_mov_b32 s20, 0
    s_mov_b64 s[62:63], 0
    s_barrier
    ds_read_b32 v18, v6
    ds_read_b32 v10, v2 offset:0
    ds_read_b32 v12, v2 offset:128
    ds_read_b128 v[48:51], v3 offset:384
    ds_read_b128 v[52:55], v3 offset:576
    ds_read_b128 v[56:59], v3 offset:448
    ds_read_b128 v[60:63], v3 offset:640
    s_waitcnt lgkmcnt(0)
    buffer_load_dwordx4 v[32:35], v[10:11], s[8:11], 0 idxen offen
    v_cmp_lt_u32 vcc, 64, v18
    s_movk_i32 s48, 96
    v_cmp_lt_u32 s[46:47], s48, v18
    v_mov_b32 v1, v18
    v_mov_b32 v18, 0
    s_and_b32 s64, vcc_lo, 16383
    s_and_b32 s46, s46, 16383
    s_or_b32 s62, s62, s46
    s_mov_b32 exec_lo, 16383
    s_mov_b32 exec_hi, 0
    ds_write_b32 v6, v18
    s_mov_b64 exec, -1
    s_mov_b32 s21, s64
    v_add_u32 v6, s56, v6
    s_sub_u32 s56, 0, s56
K2_cloop:
    s_waitcnt lgkmcnt(0)
    buffer_load_dwordx4 v[36:39], v[12:13], s[8:11], 0 idxen offen
    ds_read_b32 v10, v2 offset:784
    s_waitcnt vmcnt(1)
    v_mfma_f32_16x16x32_bf16 v[64:67], v[32:35], v[24:27], 0
    v_mfma_f32_16x16x32_bf16 v[68:71], v[32:35], v[28:31], 0
    v_lshlrev_b32 v52, v5, v52
    v_lshlrev_b32 v53, v5, v53
    v_lshlrev_b32 v54, v5, v54
    v_lshlrev_b32 v55, v5, v55
    v_pk_ashrrev_i16 v52, s57, v52
    v_pk_ashrrev_i16 v53, s57, v53
    v_pk_ashrrev_i16 v54, s57, v54
    v_pk_ashrrev_i16 v55, s57, v55
    v_and_b32 v52, v52, v48
    v_and_b32 v53, v53, v49
    v_and_b32 v54, v54, v50
    v_and_b32 v55, v55, v51
    v_cvt_pk_bf16_f32 v64, v64, v68
    v_cvt_pk_bf16_f32 v65, v65, v69
    v_cvt_pk_bf16_f32 v66, v66, v70
    v_cvt_pk_bf16_f32 v67, v67, v71
    s_nop 1
    v_mfma_f32_16x16x32_bf16 v[72:75], v[64:67], v[52:55], v[72:75]
    ds_read_b128 v[48:51], v3 offset:1168
    ds_read_b128 v[52:55], v3 offset:1360
    s_cmp_eq_u32 s21, 0
    s_cbranch_scc1 K2_noxa0
    s_ff1_i32_b32 s67, s21
    s_bitset0_b32 s21, s67
    v_readlane_b32 s68, v1, s67
    s_mul_i32 s69, s67, 784
    v_mbcnt_lo_u32_b32 v20, -1, 0
    v_mbcnt_hi_u32_b32 v20, -1, v20
    s_add_u32 s48, s70, s69
    v_add_u32 v21, 64, v20
    s_add_u32 s49, s48, 704
    s_add_u32 s48, s48, 256
    v_cmp_le_u32 vcc, s68, v21
    v_lshl_add_u32 v22, v20, 2, s48
    v_lshl_add_u32 v23, v20, 1, s49
    v_mov_b32 v21, 0
    s_mov_b32 exec_lo, vcc_lo
    s_mov_b32 exec_hi, 0
    ds_write_b32 v22, v8
    ds_write_b16 v23, v21
    s_mov_b64 exec, -1
    v_add_u32 v22, s69, v2
    ds_read_b32 v18, v22 offset:256
    s_waitcnt lgkmcnt(0)
    buffer_load_dwordx4 v[20:23], v[18:19], s[8:11], 0 idxen offen
K2_noxa0:
    s_waitcnt lgkmcnt(2)
    buffer_load_dwordx4 v[32:35], v[10:11], s[8:11], 0 idxen offen
    ds_read_b32 v12, v2 offset:912
    s_waitcnt vmcnt(1)
    v_mfma_f32_16x16x32_bf16 v[64:67], v[36:39], v[24:27], 0
    v_mfma_f32_16x16x32_bf16 v[68:71], v[36:39], v[28:31], 0
    v_lshlrev_b32 v60, v5, v60
    v_lshlrev_b32 v61, v5, v61
    v_lshlrev_b32 v62, v5, v62
    v_lshlrev_b32 v63, v5, v63
    v_pk_ashrrev_i16 v60, s57, v60
    v_pk_ashrrev_i16 v61, s57, v61
    v_pk_ashrrev_i16 v62, s57, v62
    v_pk_ashrrev_i16 v63, s57, v63
    v_and_b32 v60, v60, v56
    v_and_b32 v61, v61, v57
    v_and_b32 v62, v62, v58
    v_and_b32 v63, v63, v59
    v_cvt_pk_bf16_f32 v64, v64, v68
    v_cvt_pk_bf16_f32 v65, v65, v69
    v_cvt_pk_bf16_f32 v66, v66, v70
    v_cvt_pk_bf16_f32 v67, v67, v71
    s_nop 1
    v_mfma_f32_16x16x32_bf16 v[72:75], v[64:67], v[60:63], v[72:75]
    ds_read_b128 v[56:59], v3 offset:1232
    ds_read_b128 v[60:63], v3 offset:1424
    ds_write_b64 v4, v[8:9] offset:0
    s_waitcnt lgkmcnt(3)
    buffer_load_dwordx4 v[36:39], v[12:13], s[8:11], 0 idxen offen
    ds_read_b32 v10, v2 offset:1568
    s_waitcnt vmcnt(1)
    v_mfma_f32_16x16x32_bf16 v[64:67], v[32:35], v[24:27], 0
    v_mfma_f32_16x16x32_bf16 v[68:71], v[32:35], v[28:31], 0
    v_lshlrev_b32 v52, v5, v52
    v_lshlrev_b32 v53, v5, v53
    v_lshlrev_b32 v54, v5, v54
    v_lshlrev_b32 v55, v5, v55
    v_pk_ashrrev_i16 v52, s57, v52
    v_pk_ashrrev_i16 v53, s57, v53
    v_pk_ashrrev_i16 v54, s57, v54
    v_pk_ashrrev_i16 v55, s57, v55
    v_and_b32 v52, v52, v48
    v_and_b32 v53, v53, v49
    v_and_b32 v54, v54, v50
    v_and_b32 v55, v55, v51
    v_cvt_pk_bf16_f32 v64, v64, v68
    v_cvt_pk_bf16_f32 v65, v65, v69
    v_cvt_pk_bf16_f32 v66, v66, v70
    v_cvt_pk_bf16_f32 v67, v67, v71
    s_nop 1
    v_mfma_f32_16x16x32_bf16 v[76:79], v[64:67], v[52:55], v[76:79]
    ds_read_b128 v[48:51], v3 offset:1952
    ds_read_b128 v[52:55], v3 offset:2144
    s_waitcnt lgkmcnt(2)
    buffer_load_dwordx4 v[32:35], v[10:11], s[8:11], 0 idxen offen
    ds_read_b32 v12, v2 offset:1696
    s_waitcnt vmcnt(1)
    v_mfma_f32_16x16x32_bf16 v[64:67], v[36:39], v[24:27], 0
    v_mfma_f32_16x16x32_bf16 v[68:71], v[36:39], v[28:31], 0
    v_lshlrev_b32 v60, v5, v60
    v_lshlrev_b32 v61, v5, v61
    v_lshlrev_b32 v62, v5, v62
    v_lshlrev_b32 v63, v5, v63
    v_pk_ashrrev_i16 v60, s57, v60
    v_pk_ashrrev_i16 v61, s57, v61
    v_pk_ashrrev_i16 v62, s57, v62
    v_pk_ashrrev_i16 v63, s57, v63
    v_and_b32 v60, v60, v56
    v_and_b32 v61, v61, v57
    v_and_b32 v62, v62, v58
    v_and_b32 v63, v63, v59
    v_cvt_pk_bf16_f32 v64, v64, v68
    v_cvt_pk_bf16_f32 v65, v65, v69
    v_cvt_pk_bf16_f32 v66, v66, v70
    v_cvt_pk_bf16_f32 v67, v67, v71
    s_nop 1
    v_mfma_f32_16x16x32_bf16 v[76:79], v[64:67], v[60:63], v[76:79]
    ds_read_b128 v[56:59], v3 offset:2016
    ds_read_b128 v[60:63], v3 offset:2208
    ds_write_b64 v4, v[8:9] offset:784
    s_waitcnt lgkmcnt(3)
    buffer_load_dwordx4 v[36:39], v[12:13], s[8:11], 0 idxen offen
    ds_read_b32 v10, v2 offset:2352
    s_waitcnt vmcnt(1)
    v_mfma_f32_16x16x32_bf16 v[64:67], v[32:35], v[24:27], 0
    v_mfma_f32_16x16x32_bf16 v[68:71], v[32:35], v[28:31], 0
    v_lshlrev_b32 v52, v5, v52
    v_lshlrev_b32 v53, v5, v53
    v_lshlrev_b32 v54, v5, v54
    v_lshlrev_b32 v55, v5, v55
    v_pk_ashrrev_i16 v52, s57, v52
    v_pk_ashrrev_i16 v53, s57, v53
    v_pk_ashrrev_i16 v54, s57, v54
    v_pk_ashrrev_i16 v55, s57, v55
    v_and_b32 v52, v52, v48
    v_and_b32 v53, v53, v49
    v_and_b32 v54, v54, v50
    v_and_b32 v55, v55, v51
    v_cvt_pk_bf16_f32 v64, v64, v68
    v_cvt_pk_bf16_f32 v65, v65, v69
    v_cvt_pk_bf16_f32 v66, v66, v70
    v_cvt_pk_bf16_f32 v67, v67, v71
    s_nop 1
    v_mfma_f32_16x16x32_bf16 v[80:83], v[64:67], v[52:55], v[80:83]
    ds_read_b128 v[48:51], v3 offset:2736
    ds_read_b128 v[52:55], v3 offset:2928
    s_waitcnt lgkmcnt(2)
    buffer_load_dwordx4 v[32:35], v[10:11], s[8:11], 0 idxen offen
    ds_read_b32 v12, v2 offset:2480
    s_waitcnt vmcnt(1)
    v_mfma_f32_16x16x32_bf16 v[64:67], v[36:39], v[24:27], 0
    v_mfma_f32_16x16x32_bf16 v[68:71], v[36:39], v[28:31], 0
    v_lshlrev_b32 v60, v5, v60
    v_lshlrev_b32 v61, v5, v61
    v_lshlrev_b32 v62, v5, v62
    v_lshlrev_b32 v63, v5, v63
    v_pk_ashrrev_i16 v60, s57, v60
    v_pk_ashrrev_i16 v61, s57, v61
    v_pk_ashrrev_i16 v62, s57, v62
    v_pk_ashrrev_i16 v63, s57, v63
    v_and_b32 v60, v60, v56
    v_and_b32 v61, v61, v57
    v_and_b32 v62, v62, v58
    v_and_b32 v63, v63, v59
    v_cvt_pk_bf16_f32 v64, v64, v68
    v_cvt_pk_bf16_f32 v65, v65, v69
    v_cvt_pk_bf16_f32 v66, v66, v70
    v_cvt_pk_bf16_f32 v67, v67, v71
    s_nop 1
    v_mfma_f32_16x16x32_bf16 v[80:83], v[64:67], v[60:63], v[80:83]
    ds_read_b128 v[56:59], v3 offset:2800
    ds_read_b128 v[60:63], v3 offset:2992
    ds_write_b64 v4, v[8:9] offset:1568
    s_waitcnt lgkmcnt(3)
    buffer_load_dwordx4 v[36:39], v[12:13], s[8:11], 0 idxen offen
    ds_read_b32 v10, v2 offset:3136
    s_waitcnt vmcnt(1)
    v_mfma_f32_16x16x32_bf16 v[64:67], v[32:35], v[24:27], 0
    v_mfma_f32_16x16x32_bf16 v[68:71], v[32:35], v[28:31], 0
    v_lshlrev_b32 v52, v5, v52
    v_lshlrev_b32 v53, v5, v53
    v_lshlrev_b32 v54, v5, v54
    v_lshlrev_b32 v55, v5, v55
    v_pk_ashrrev_i16 v52, s57, v52
    v_pk_ashrrev_i16 v53, s57, v53
    v_pk_ashrrev_i16 v54, s57, v54
    v_pk_ashrrev_i16 v55, s57, v55
    v_and_b32 v52, v52, v48
    v_and_b32 v53, v53, v49
    v_and_b32 v54, v54, v50
    v_and_b32 v55, v55, v51
    v_cvt_pk_bf16_f32 v64, v64, v68
    v_cvt_pk_bf16_f32 v65, v65, v69
    v_cvt_pk_bf16_f32 v66, v66, v70
    v_cvt_pk_bf16_f32 v67, v67, v71
    s_nop 1
    v_mfma_f32_16x16x32_bf16 v[84:87], v[64:67], v[52:55], v[84:87]
    ds_read_b128 v[48:51], v3 offset:3520
    ds_read_b128 v[52:55], v3 offset:3712
    s_waitcnt lgkmcnt(2)
    buffer_load_dwordx4 v[32:35], v[10:11], s[8:11], 0 idxen offen
    ds_read_b32 v12, v2 offset:3264
    s_waitcnt vmcnt(1)
    v_mfma_f32_16x16x32_bf16 v[64:67], v[36:39], v[24:27], 0
    v_mfma_f32_16x16x32_bf16 v[68:71], v[36:39], v[28:31], 0
    v_lshlrev_b32 v60, v5, v60
    v_lshlrev_b32 v61, v5, v61
    v_lshlrev_b32 v62, v5, v62
    v_lshlrev_b32 v63, v5, v63
    v_pk_ashrrev_i16 v60, s57, v60
    v_pk_ashrrev_i16 v61, s57, v61
    v_pk_ashrrev_i16 v62, s57, v62
    v_pk_ashrrev_i16 v63, s57, v63
    v_and_b32 v60, v60, v56
    v_and_b32 v61, v61, v57
    v_and_b32 v62, v62, v58
    v_and_b32 v63, v63, v59
    v_cvt_pk_bf16_f32 v64, v64, v68
    v_cvt_pk_bf16_f32 v65, v65, v69
    v_cvt_pk_bf16_f32 v66, v66, v70
    v_cvt_pk_bf16_f32 v67, v67, v71
    s_nop 1
    v_mfma_f32_16x16x32_bf16 v[84:87], v[64:67], v[60:63], v[84:87]
    ds_read_b128 v[56:59], v3 offset:3584
    ds_read_b128 v[60:63], v3 offset:3776
    ds_write_b64 v4, v[8:9] offset:2352
    s_cmp_lt_i32 s67, 0
    s_cbranch_scc1 K2_noxb0
    v_mfma_f32_16x16x32_bf16 v[64:67], v[20:23], v[24:27], 0
    v_mfma_f32_16x16x32_bf16 v[68:71], v[20:23], v[28:31], 0
    v_add_u32 v18, s69, v3
    s_nop 7
    v_cvt_pk_bf16_f32 v64, v64, v68
    v_cvt_pk_bf16_f32 v65, v65, v69
    v_cvt_pk_bf16_f32 v66, v66, v70
    v_cvt_pk_bf16_f32 v67, v67, v71
    ds_read_b128 v[20:23], v18 offset:512
    ds_read_b128 v[68:71], v18 offset:704
    s_waitcnt lgkmcnt(0)
    v_lshlrev_b32 v68, v5, v68
    v_lshlrev_b32 v69, v5, v69
    v_lshlrev_b32 v70, v5, v70
    v_lshlrev_b32 v71, v5, v71
    v_pk_ashrrev_i16 v68, s57, v68
    v_pk_ashrrev_i16 v69, s57, v69
    v_pk_ashrrev_i16 v70, s57, v70
    v_pk_ashrrev_i16 v71, s57, v71
    v_and_b32 v68, v68, v20
    v_and_b32 v69, v69, v21
    v_and_b32 v70, v70, v22
    v_and_b32 v71, v71, v23
    s_cmp_eq_u32 s67, 0
    s_cbranch_scc0 K2_xja0_0
    v_mfma_f32_16x16x32_bf16 v[72:75], v[64:67], v[68:71], v[72:75]
    s_branch K2_xdonea0
K2_xja0_0:
    s_cmp_eq_u32 s67, 1
    s_cbranch_scc0 K2_xja0_1
    v_mfma_f32_16x16x32_bf16 v[76:79], v[64:67], v[68:71], v[76:79]
    s_branch K2_xdonea0
K2_xja0_1:
    s_cmp_eq_u32 s67, 2
    s_cbranch_scc0 K2_xja0_2
    v_mfma_f32_16x16x32_bf16 v[80:83], v[64:67], v[68:71], v[80:83]
    s_branch K2_xdonea0
K2_xja0_2:
    s_cmp_eq_u32 s67, 3
    s_cbranch_scc0 K2_xja0_3
    v_mfma_f32_16x16x32_bf16 v[84:87], v[64:67], v[68:71], v[84:87]
    s_branch K2_xdonea0
K2_xja0_3:
    s_cmp_eq_u32 s67, 4
    s_cbranch_scc0 K2_xja0_4
    v_mfma_f32_16x16x32_bf16 v[88:91], v[64:67], v[68:71], v[88:91]
    s_branch K2_xdonea0
K2_xja0_4:
    s_cmp_eq_u32 s67, 5
    s_cbranch_scc0 K2_xja0_5
    v_mfma_f32_16x16x32_bf16 v[92:95], v[64:67], v[68:71], v[92:95]
    s_branch K2_xdonea0
K2_xja0_5:
    s_cmp_eq_u32 s67, 6
    s_cbranch_scc0 K2_xja0_6
    v_mfma_f32_16x16x32_bf16 v[96:99], v[64:67], v[68:71], v[96:99]
    s_branch K2_xdonea0
K2_xja0_6:
    s_cmp_eq_u32 s67, 7
    s_cbranch_scc0 K2_xja0_7
    v_mfma_f32_16x16x32_bf16 v[100:103], v[64:67], v[68:71], v[100:103]
    s_branch K2_xdonea0
K2_xja0_7:
    s_cmp_eq_u32 s67, 8
    s_cbranch_scc0 K2_xja0_8
    v_mfma_f32_16x16x32_bf16 v[104:107], v[64:67], v[68:71], v[104:107]
    s_branch K2_xdonea0
K2_xja0_8:
    s_cmp_eq_u32 s67, 9
    s_cbranch_scc0 K2_xja0_9
    v_mfma_f32_16x16x32_bf16 v[108:111], v[64:67], v[68:71], v[108:111]
    s_branch K2_xdonea0
K2_xja0_9:
    s_cmp_eq_u32 s67, 10
    s_cbranch_scc0 K2_xja0_10
    v_mfma_f32_16x16x32_bf16 v[112:115], v[64:67], v[68:71], v[112:115]
    s_branch K2_xdonea0
K2_xja0_10:
    s_cmp_eq_u32 s67, 11
    s_cbranch_scc0 K2_xja0_11
    v_mfma_f32_16x16x32_bf16 v[116:119], v[64:67], v[68:71], v[116:119]
    s_branch K2_xdonea0
K2_xja0_11:
    s_cmp_eq_u32 s67, 12
    s_cbranch_scc0 K2_xja0_12
    v_mfma_f32_16x16x32_bf16 v[120:123], v[64:67], v[68:71], v[120:123]
    s_branch K2_xdonea0
K2_xja0_12:
    s_cmp_eq_u32 s67, 13
    s_cbranch_scc0 K2_xja0_13
    v_mfma_f32_16x16x32_bf16 v[124:127], v[64:67], v[68:71], v[124:127]
    s_branch K2_xdonea0
K2_xja0_13:
K2_xdonea0:
    s_mov_b32 s67, -1
K2_noxb0:
    s_waitcnt lgkmcnt(3)
    buffer_load_dwordx4 v[36:39], v[12:13], s[8:11], 0 idxen offen
    ds_read_b32 v10, v2 offset:3920
    s_waitcnt vmcnt(1)
    v_mfma_f32_16x16x32_bf16 v[64:67], v[32:35], v[24:27], 0
    v_mfma_f32_16x16x32_bf16 v[68:71], v[32:35], v[28:31], 0
    v_lshlrev_b32 v52, v5, v52
    v_lshlrev_b32 v53, v5, v53
    v_lshlrev_b32 v54, v5, v54
    v_lshlrev_b32 v55, v5, v55
    v_pk_ashrrev_i16 v52, s57, v52
    v_pk_ashrrev_i16 v53, s57, v53
    v_pk_ashrrev_i16 v54, s57, v54
    v_pk_ashrrev_i16 v55, s57, v55
    v_and_b32 v52, v52, v48
    v_and_b32 v53, v53, v49
    v_and_b32 v54, v54, v50
    v_and_b32 v55, v55, v51
    v_cvt_pk_bf16_f32 v64, v64, v68
    v_cvt_pk_bf16_f32 v65, v65, v69
    v_cvt_pk_bf16_f32 v66, v66, v70
    v_cvt_pk_bf16_f32 v67, v67, v71
    s_nop 1
    v_mfma_f32_16x16x32_bf16 v[88:91], v[64:67], v[52:55], v[88:91]
    ds_read_b128 v[48:51], v3 offset:4304
    ds_read_b128 v[52:55], v3 offset:4496
    s_waitcnt lgkmcnt(2)
    buffer_load_dwordx4 v[32:35], v[10:11], s[8:11], 0 idxen offen
    ds_read_b32 v12, v2 offset:4048
    s_waitcnt vmcnt(1)
    v_mfma_f32_16x16x32_bf16 v[64:67], v[36:39], v[24:27], 0
    v_mfma_f32_16x16x32_bf16 v[68:71], v[36:39], v[28:31], 0
    v_lshlrev_b32 v60, v5, v60
    v_lshlrev_b32 v61, v5, v61
    v_lshlrev_b32 v62, v5, v62
    v_lshlrev_b32 v63, v5, v63
    v_pk_ashrrev_i16 v60, s57, v60
    v_pk_ashrrev_i16 v61, s57, v61
    v_pk_ashrrev_i16 v62, s57, v62
    v_pk_ashrrev_i16 v63, s57, v63
    v_and_b32 v60, v60, v56
    v_and_b32 v61, v61, v57
    v_and_b32 v62, v62, v58
    v_and_b32 v63, v63, v59
    v_cvt_pk_bf16_f32 v64, v64, v68
    v_cvt_pk_bf16_f32 v65, v65, v69
    v_cvt_pk_bf16_f32 v66, v66, v70
    v_cvt_pk_bf16_f32 v67, v67, v71
    s_nop 1
    v_mfma_f32_16x16x32_bf16 v[88:91], v[64:67], v[60:63], v[88:91]
    ds_read_b128 v[56:59], v3 offset:4368
    ds_read_b128 v[60:63], v3 offset:4560
    ds_write_b64 v4, v[8:9] offset:3136
    s_waitcnt lgkmcnt(3)
    buffer_load_dwordx4 v[36:39], v[12:13], s[8:11], 0 idxen offen
    ds_read_b32 v10, v2 offset:4704
    s_waitcnt vmcnt(1)
    v_mfma_f32_16x16x32_bf16 v[64:67], v[32:35], v[24:27], 0
    v_mfma_f32_16x16x32_bf16 v[68:71], v[32:35], v[28:31], 0
    v_lshlrev_b32 v52, v5, v52
    v_lshlrev_b32 v53, v5, v53
    v_lshlrev_b32 v54, v5, v54
    v_lshlrev_b32 v55, v5, v55
    v_pk_ashrrev_i16 v52, s57, v52
    v_pk_ashrrev_i16 v53, s57, v53
    v_pk_ashrrev_i16 v54, s57, v54
    v_pk_ashrrev_i16 v55, s57, v55
    v_and_b32 v52, v52, v48
    v_and_b32 v53, v53, v49
    v_and_b32 v54, v54, v50
    v_and_b32 v55, v55, v51
    v_cvt_pk_bf16_f32 v64, v64, v68
    v_cvt_pk_bf16_f32 v65, v65, v69
    v_cvt_pk_bf16_f32 v66, v66, v70
    v_cvt_pk_bf16_f32 v67, v67, v71
    s_nop 1
    v_mfma_f32_16x16x32_bf16 v[92:95], v[64:67], v[52:55], v[92:95]
    ds_read_b128 v[48:51], v3 offset:5088
    ds_read_b128 v[52:55], v3 offset:5280
    s_waitcnt lgkmcnt(2)
    buffer_load_dwordx4 v[32:35], v[10:11], s[8:11], 0 idxen offen
    ds_read_b32 v12, v2 offset:4832
    s_waitcnt vmcnt(1)
    v_mfma_f32_16x16x32_bf16 v[64:67], v[36:39], v[24:27], 0
    v_mfma_f32_16x16x32_bf16 v[68:71], v[36:39], v[28:31], 0
    v_lshlrev_b32 v60, v5, v60
    v_lshlrev_b32 v61, v5, v61
    v_lshlrev_b32 v62, v5, v62
    v_lshlrev_b32 v63, v5, v63
    v_pk_ashrrev_i16 v60, s57, v60
    v_pk_ashrrev_i16 v61, s57, v61
    v_pk_ashrrev_i16 v62, s57, v62
    v_pk_ashrrev_i16 v63, s57, v63
    v_and_b32 v60, v60, v56
    v_and_b32 v61, v61, v57
    v_and_b32 v62, v62, v58
    v_and_b32 v63, v63, v59
    v_cvt_pk_bf16_f32 v64, v64, v68
    v_cvt_pk_bf16_f32 v65, v65, v69
    v_cvt_pk_bf16_f32 v66, v66, v70
    v_cvt_pk_bf16_f32 v67, v67, v71
    s_nop 1
    v_mfma_f32_16x16x32_bf16 v[92:95], v[64:67], v[60:63], v[92:95]
    ds_read_b128 v[56:59], v3 offset:5152
    ds_read_b128 v[60:63], v3 offset:5344
    ds_write_b64 v4, v[8:9] offset:3920
    s_waitcnt lgkmcnt(3)
    buffer_load_dwordx4 v[36:39], v[12:13], s[8:11], 0 idxen offen
    ds_read_b32 v10, v2 offset:5488
    s_waitcnt vmcnt(1)
    v_mfma_f32_16x16x32_bf16 v[64:67], v[32:35], v[24:27], 0
    v_mfma_f32_16x16x32_bf16 v[68:71], v[32:35], v[28:31], 0
    v_lshlrev_b32 v52, v5, v52
    v_lshlrev_b32 v53, v5, v53
    v_lshlrev_b32 v54, v5, v54
    v_lshlrev_b32 v55, v5, v55
    v_pk_ashrrev_i16 v52, s57, v52
    v_pk_ashrrev_i16 v53, s57, v53
    v_pk_ashrrev_i16 v54, s57, v54
    v_pk_ashrrev_i16 v55, s57, v55
    v_and_b32 v52, v52, v48
    v_and_b32 v53, v53, v49
    v_and_b32 v54, v54, v50
    v_and_b32 v55, v55, v51
    v_cvt_pk_bf16_f32 v64, v64, v68
    v_cvt_pk_bf16_f32 v65, v65, v69
    v_cvt_pk_bf16_f32 v66, v66, v70
    v_cvt_pk_bf16_f32 v67, v67, v71
    s_nop 1
    v_mfma_f32_16x16x32_bf16 v[96:99], v[64:67], v[52:55], v[96:99]
    ds_read_b128 v[48:51], v3 offset:5872
    ds_read_b128 v[52:55], v3 offset:6064
    s_waitcnt lgkmcnt(2)
    buffer_load_dwordx4 v[32:35], v[10:11], s[8:11], 0 idxen offen
    ds_read_b32 v12, v2 offset:5616
    s_waitcnt vmcnt(1)
    v_mfma_f32_16x16x32_bf16 v[64:67], v[36:39], v[24:27], 0
    v_mfma_f32_16x16x32_bf16 v[68:71], v[36:39], v[28:31], 0
    v_lshlrev_b32 v60, v5, v60
    v_lshlrev_b32 v61, v5, v61
    v_lshlrev_b32 v62, v5, v62
    v_lshlrev_b32 v63, v5, v63
    v_pk_ashrrev_i16 v60, s57, v60
    v_pk_ashrrev_i16 v61, s57, v61
    v_pk_ashrrev_i16 v62, s57, v62
    v_pk_ashrrev_i16 v63, s57, v63
    v_and_b32 v60, v60, v56
    v_and_b32 v61, v61, v57
    v_and_b32 v62, v62, v58
    v_and_b32 v63, v63, v59
    v_cvt_pk_bf16_f32 v64, v64, v68
    v_cvt_pk_bf16_f32 v65, v65, v69
    v_cvt_pk_bf16_f32 v66, v66, v70
    v_cvt_pk_bf16_f32 v67, v67, v71
    s_nop 1
    v_mfma_f32_16x16x32_bf16 v[96:99], v[64:67], v[60:63], v[96:99]
    ds_read_b128 v[56:59], v3 offset:5936
    ds_read_b128 v[60:63], v3 offset:6128
    ds_write_b64 v4, v[8:9] offset:4704
    s_waitcnt lgkmcnt(3)
    buffer_load_dwordx4 v[36:39], v[12:13], s[8:11], 0 idxen offen
    ds_read_b32 v10, v2 offset:6272
    s_waitcnt vmcnt(1)
    v_mfma_f32_16x16x32_bf16 v[64:67], v[32:35], v[24:27], 0
    v_mfma_f32_16x16x32_bf16 v[68:71], v[32:35], v[28:31], 0
    v_lshlrev_b32 v52, v5, v52
    v_lshlrev_b32 v53, v5, v53
    v_lshlrev_b32 v54, v5, v54
    v_lshlrev_b32 v55, v5, v55
    v_pk_ashrrev_i16 v52, s57, v52
    v_pk_ashrrev_i16 v53, s57, v53
    v_pk_ashrrev_i16 v54, s57, v54
    v_pk_ashrrev_i16 v55, s57, v55
    v_and_b32 v52, v52, v48
    v_and_b32 v53, v53, v49
    v_and_b32 v54, v54, v50
    v_and_b32 v55, v55, v51
    v_cvt_pk_bf16_f32 v64, v64, v68
    v_cvt_pk_bf16_f32 v65, v65, v69
    v_cvt_pk_bf16_f32 v66, v66, v70
    v_cvt_pk_bf16_f32 v67, v67, v71
    s_nop 1
    v_mfma_f32_16x16x32_bf16 v[100:103], v[64:67], v[52:55], v[100:103]
    ds_read_b128 v[48:51], v3 offset:6656
    ds_read_b128 v[52:55], v3 offset:6848
    s_waitcnt lgkmcnt(2)
    buffer_load_dwordx4 v[32:35], v[10:11], s[8:11], 0 idxen offen
    ds_read_b32 v12, v2 offset:6400
    s_waitcnt vmcnt(1)
    v_mfma_f32_16x16x32_bf16 v[64:67], v[36:39], v[24:27], 0
    v_mfma_f32_16x16x32_bf16 v[68:71], v[36:39], v[28:31], 0
    v_lshlrev_b32 v60, v5, v60
    v_lshlrev_b32 v61, v5, v61
    v_lshlrev_b32 v62, v5, v62
    v_lshlrev_b32 v63, v5, v63
    v_pk_ashrrev_i16 v60, s57, v60
    v_pk_ashrrev_i16 v61, s57, v61
    v_pk_ashrrev_i16 v62, s57, v62
    v_pk_ashrrev_i16 v63, s57, v63
    v_and_b32 v60, v60, v56
    v_and_b32 v61, v61, v57
    v_and_b32 v62, v62, v58
    v_and_b32 v63, v63, v59
    v_cvt_pk_bf16_f32 v64, v64, v68
    v_cvt_pk_bf16_f32 v65, v65, v69
    v_cvt_pk_bf16_f32 v66, v66, v70
    v_cvt_pk_bf16_f32 v67, v67, v71
    s_nop 1
    v_mfma_f32_16x16x32_bf16 v[100:103], v[64:67], v[60:63], v[100:103]
    ds_read_b128 v[56:59], v3 offset:6720
    ds_read_b128 v[60:63], v3 offset:6912
    ds_write_b64 v4, v[8:9] offset:5488
    s_waitcnt lgkmcnt(3)
    buffer_load_dwordx4 v[36:39], v[12:13], s[8:11], 0 idxen offen
    ds_read_b32 v10, v2 offset:7056
    s_waitcnt vmcnt(1)
    v_mfma_f32_16x16x32_bf16 v[64:67], v[32:35], v[24:27], 0
    v_mfma_f32_16x16x32_bf16 v[68:71], v[32:35], v[28:31], 0
    v_lshlrev_b32 v52, v5, v52
    v_lshlrev_b32 v53, v5, v53
    v_lshlrev_b32 v54, v5, v54
    v_lshlrev_b32 v55, v5, v55
    v_pk_ashrrev_i16 v52, s57, v52
    v_pk_ashrrev_i16 v53, s57, v53
    v_pk_ashrrev_i16 v54, s57, v54
    v_pk_ashrrev_i16 v55, s57, v55
    v_and_b32 v52, v52, v48
    v_and_b32 v53, v53, v49
    v_and_b32 v54, v54, v50
    v_and_b32 v55, v55, v51
    v_cvt_pk_bf16_f32 v64, v64, v68
    v_cvt_pk_bf16_f32 v65, v65, v69
    v_cvt_pk_bf16_f32 v66, v66, v70
    v_cvt_pk_bf16_f32 v67, v67, v71
    s_nop 1
    v_mfma_f32_16x16x32_bf16 v[104:107], v[64:67], v[52:55], v[104:107]
    ds_read_b128 v[48:51], v3 offset:7440
    ds_read_b128 v[52:55], v3 offset:7632
    s_waitcnt lgkmcnt(2)
    buffer_load_dwordx4 v[32:35], v[10:11], s[8:11], 0 idxen offen
    ds_read_b32 v12, v2 offset:7184
    s_waitcnt vmcnt(1)
    v_mfma_f32_16x16x32_bf16 v[64:67], v[36:39], v[24:27], 0
    v_mfma_f32_16x16x32_bf16 v[68:71], v[36:39], v[28:31], 0
    v_lshlrev_b32 v60, v5, v60
    v_lshlrev_b32 v61, v5, v61
    v_lshlrev_b32 v62, v5, v62
    v_lshlrev_b32 v63, v5, v63
    v_pk_ashrrev_i16 v60, s57, v60
    v_pk_ashrrev_i16 v61, s57, v61
    v_pk_ashrrev_i16 v62, s57, v62
    v_pk_ashrrev_i16 v63, s57, v63
    v_and_b32 v60, v60, v56
    v_and_b32 v61, v61, v57
    v_and_b32 v62, v62, v58
    v_and_b32 v63, v63, v59
    v_cvt_pk_bf16_f32 v64, v64, v68
    v_cvt_pk_bf16_f32 v65, v65, v69
    v_cvt_pk_bf16_f32 v66, v66, v70
    v_cvt_pk_bf16_f32 v67, v67, v71
    s_nop 1
    v_mfma_f32_16x16x32_bf16 v[104:107], v[64:67], v[60:63], v[104:107]
    ds_read_b128 v[56:59], v3 offset:7504
    ds_read_b128 v[60:63], v3 offset:7696
    ds_write_b64 v4, v[8:9] offset:6272
K2_xloop0:
    s_cmp_eq_u32 s21, 0
    s_cbranch_scc1 K2_noxc0
    s_ff1_i32_b32 s67, s21
    s_bitset0_b32 s21, s67
    v_readlane_b32 s68, v1, s67
    s_mul_i32 s69, s67, 784
    v_mbcnt_lo_u32_b32 v20, -1, 0
    v_mbcnt_hi_u32_b32 v20, -1, v20
    s_add_u32 s48, s70, s69
    v_add_u32 v21, 64, v20
    s_add_u32 s49, s48, 704
    s_add_u32 s48, s48, 256
    v_cmp_le_u32 vcc, s68, v21
    v_lshl_add_u32 v22, v20, 2, s48
    v_lshl_add_u32 v23, v20, 1, s49
    v_mov_b32 v21, 0
    s_mov_b32 exec_lo, vcc_lo
    s_mov_b32 exec_hi, 0
    ds_write_b32 v22, v8
    ds_write_b16 v23, v21
    s_mov_b64 exec, -1
    v_add_u32 v22, s69, v2
    ds_read_b32 v18, v22 offset:256
    s_waitcnt lgkmcnt(0)
    buffer_load_dwordx4 v[20:23], v[18:19], s[8:11], 0 idxen offen
    s_waitcnt vmcnt(0)
    v_mfma_f32_16x16x32_bf16 v[64:67], v[20:23], v[24:27], 0
    v_mfma_f32_16x16x32_bf16 v[68:71], v[20:23], v[28:31], 0
    v_add_u32 v18, s69, v3
    s_nop 7
    v_cvt_pk_bf16_f32 v64, v64, v68
    v_cvt_pk_bf16_f32 v65, v65, v69
    v_cvt_pk_bf16_f32 v66, v66, v70
    v_cvt_pk_bf16_f32 v67, v67, v71
    ds_read_b128 v[20:23], v18 offset:512
    ds_read_b128 v[68:71], v18 offset:704
    s_waitcnt lgkmcnt(0)
    v_lshlrev_b32 v68, v5, v68
    v_lshlrev_b32 v69, v5, v69
    v_lshlrev_b32 v70, v5, v70
    v_lshlrev_b32 v71, v5, v71
    v_pk_ashrrev_i16 v68, s57, v68
    v_pk_ashrrev_i16 v69, s57, v69
    v_pk_ashrrev_i16 v70, s57, v70
    v_pk_ashrrev_i16 v71, s57, v71
    v_and_b32 v68, v68, v20
    v_and_b32 v69, v69, v21
    v_and_b32 v70, v70, v22
    v_and_b32 v71, v71, v23
    s_cmp_eq_u32 s67, 0
    s_cbranch_scc0 K2_xjc0_0
    v_mfma_f32_16x16x32_bf16 v[72:75], v[64:67], v[68:71], v[72:75]
    s_branch K2_xdonec0
K2_xjc0_0:
    s_cmp_eq_u32 s67, 1
    s_cbranch_scc0 K2_xjc0_1
    v_mfma_f32_16x16x32_bf16 v[76:79], v[64:67], v[68:71], v[76:79]
    s_branch K2_xdonec0
K2_xjc0_1:
    s_cmp_eq_u32 s67, 2
    s_cbranch_scc0 K2_xjc0_2
    v_mfma_f32_16x16x32_bf16 v[80:83], v[64:67], v[68:71], v[80:83]
    s_branch K2_xdonec0
K2_xjc0_2:
    s_cmp_eq_u32 s67, 3
    s_cbranch_scc0 K2_xjc0_3
    v_mfma_f32_16x16x32_bf16 v[84:87], v[64:67], v[68:71], v[84:87]
    s_branch K2_xdonec0
K2_xjc0_3:
    s_cmp_eq_u32 s67, 4
    s_cbranch_scc0 K2_xjc0_4
    v_mfma_f32_16x16x32_bf16 v[88:91], v[64:67], v[68:71], v[88:91]
    s_branch K2_xdonec0
K2_xjc0_4:
    s_cmp_eq_u32 s67, 5
    s_cbranch_scc0 K2_xjc0_5
    v_mfma_f32_16x16x32_bf16 v[92:95], v[64:67], v[68:71], v[92:95]
    s_branch K2_xdonec0
K2_xjc0_5:
    s_cmp_eq_u32 s67, 6
    s_cbranch_scc0 K2_xjc0_6
    v_mfma_f32_16x16x32_bf16 v[96:99], v[64:67], v[68:71], v[96:99]
    s_branch K2_xdonec0
K2_xjc0_6:
    s_cmp_eq_u32 s67, 7
    s_cbranch_scc0 K2_xjc0_7
    v_mfma_f32_16x16x32_bf16 v[100:103], v[64:67], v[68:71], v[100:103]
    s_branch K2_xdonec0
K2_xjc0_7:
    s_cmp_eq_u32 s67, 8
    s_cbranch_scc0 K2_xjc0_8
    v_mfma_f32_16x16x32_bf16 v[104:107], v[64:67], v[68:71], v[104:107]
    s_branch K2_xdonec0
K2_xjc0_8:
    s_cmp_eq_u32 s67, 9
    s_cbranch_scc0 K2_xjc0_9
    v_mfma_f32_16x16x32_bf16 v[108:111], v[64:67], v[68:71], v[108:111]
    s_branch K2_xdonec0
K2_xjc0_9:
    s_cmp_eq_u32 s67, 10
    s_cbranch_scc0 K2_xjc0_10
    v_mfma_f32_16x16x32_bf16 v[112:115], v[64:67], v[68:71], v[112:115]
    s_branch K2_xdonec0
K2_xjc0_10:
    s_cmp_eq_u32 s67, 11
    s_cbranch_scc0 K2_xjc0_11
    v_mfma_f32_16x16x32_bf16 v[116:119], v[64:67], v[68:71], v[116:119]
    s_branch K2_xdonec0
K2_xjc0_11:
    s_cmp_eq_u32 s67, 12
    s_cbranch_scc0 K2_xjc0_12
    v_mfma_f32_16x16x32_bf16 v[120:123], v[64:67], v[68:71], v[120:123]
    s_branch K2_xdonec0
K2_xjc0_12:
    s_cmp_eq_u32 s67, 13
    s_cbranch_scc0 K2_xjc0_13
    v_mfma_f32_16x16x32_bf16 v[124:127], v[64:67], v[68:71], v[124:127]
    s_branch K2_xdonec0
K2_xjc0_13:
K2_xdonec0:
    s_mov_b32 s67, -1
    s_branch K2_xloop0
K2_noxc0:
    s_waitcnt lgkmcnt(3)
    buffer_load_dwordx4 v[36:39], v[12:13], s[8:11], 0 idxen offen
    ds_read_b32 v10, v2 offset:7840
    s_waitcnt vmcnt(1)
    v_mfma_f32_16x16x32_bf16 v[64:67], v[32:35], v[24:27], 0
    v_mfma_f32_16x16x32_bf16 v[68:71], v[32:35], v[28:31], 0
    v_lshlrev_b32 v52, v5, v52
    v_lshlrev_b32 v53, v5, v53
    v_lshlrev_b32 v54, v5, v54
    v_lshlrev_b32 v55, v5, v55
    v_pk_ashrrev_i16 v52, s57, v52
    v_pk_ashrrev_i16 v53, s57, v53
    v_pk_ashrrev_i16 v54, s57, v54
    v_pk_ashrrev_i16 v55, s57, v55
    v_and_b32 v52, v52, v48
    v_and_b32 v53, v53, v49
    v_and_b32 v54, v54, v50
    v_and_b32 v55, v55, v51
    v_cvt_pk_bf16_f32 v64, v64, v68
    v_cvt_pk_bf16_f32 v65, v65, v69
    v_cvt_pk_bf16_f32 v66, v66, v70
    v_cvt_pk_bf16_f32 v67, v67, v71
    s_nop 1
    v_mfma_f32_16x16x32_bf16 v[108:111], v[64:67], v[52:55], v[108:111]
    ds_read_b128 v[48:51], v3 offset:8224
    ds_read_b128 v[52:55], v3 offset:8416
    s_waitcnt lgkmcnt(2)
    buffer_load_dwordx4 v[32:35], v[10:11], s[8:11], 0 idxen offen
    ds_read_b32 v12, v2 offset:7968
    s_waitcnt vmcnt(1)
    v_mfma_f32_16x16x32_bf16 v[64:67], v[36:39], v[24:27], 0
    v_mfma_f32_16x16x32_bf16 v[68:71], v[36:39], v[28:31], 0
    v_lshlrev_b32 v60, v5, v60
    v_lshlrev_b32 v61, v5, v61
    v_lshlrev_b32 v62, v5, v62
    v_lshlrev_b32 v63, v5, v63
    v_pk_ashrrev_i16 v60, s57, v60
    v_pk_ashrrev_i16 v61, s57, v61
    v_pk_ashrrev_i16 v62, s57, v62
    v_pk_ashrrev_i16 v63, s57, v63
    v_and_b32 v60, v60, v56
    v_and_b32 v61, v61, v57
    v_and_b32 v62, v62, v58
    v_and_b32 v63, v63, v59
    v_cvt_pk_bf16_f32 v64, v64, v68
    v_cvt_pk_bf16_f32 v65, v65, v69
    v_cvt_pk_bf16_f32 v66, v66, v70
    v_cvt_pk_bf16_f32 v67, v67, v71
    s_nop 1
    v_mfma_f32_16x16x32_bf16 v[108:111], v[64:67], v[60:63], v[108:111]
    ds_read_b128 v[56:59], v3 offset:8288
    ds_read_b128 v[60:63], v3 offset:8480
    ds_write_b64 v4, v[8:9] offset:7056
    s_waitcnt lgkmcnt(3)
    buffer_load_dwordx4 v[36:39], v[12:13], s[8:11], 0 idxen offen
    ds_read_b32 v10, v2 offset:8624
    s_waitcnt vmcnt(1)
    v_mfma_f32_16x16x32_bf16 v[64:67], v[32:35], v[24:27], 0
    v_mfma_f32_16x16x32_bf16 v[68:71], v[32:35], v[28:31], 0
    v_lshlrev_b32 v52, v5, v52
    v_lshlrev_b32 v53, v5, v53
    v_lshlrev_b32 v54, v5, v54
    v_lshlrev_b32 v55, v5, v55
    v_pk_ashrrev_i16 v52, s57, v52
    v_pk_ashrrev_i16 v53, s57, v53
    v_pk_ashrrev_i16 v54, s57, v54
    v_pk_ashrrev_i16 v55, s57, v55
    v_and_b32 v52, v52, v48
    v_and_b32 v53, v53, v49
    v_and_b32 v54, v54, v50
    v_and_b32 v55, v55, v51
    v_cvt_pk_bf16_f32 v64, v64, v68
    v_cvt_pk_bf16_f32 v65, v65, v69
    v_cvt_pk_bf16_f32 v66, v66, v70
    v_cvt_pk_bf16_f32 v67, v67, v71
    s_nop 1
    v_mfma_f32_16x16x32_bf16 v[112:115], v[64:67], v[52:55], v[112:115]
    ds_read_b128 v[48:51], v3 offset:9008
    ds_read_b128 v[52:55], v3 offset:9200
    s_waitcnt lgkmcnt(2)
    buffer_load_dwordx4 v[32:35], v[10:11], s[8:11], 0 idxen offen
    ds_read_b32 v12, v2 offset:8752
    s_waitcnt vmcnt(1)
    v_mfma_f32_16x16x32_bf16 v[64:67], v[36:39], v[24:27], 0
    v_mfma_f32_16x16x32_bf16 v[68:71], v[36:39], v[28:31], 0
    v_lshlrev_b32 v60, v5, v60
    v_lshlrev_b32 v61, v5, v61
    v_lshlrev_b32 v62, v5, v62
    v_lshlrev_b32 v63, v5, v63
    v_pk_ashrrev_i16 v60, s57, v60
    v_pk_ashrrev_i16 v61, s57, v61
    v_pk_ashrrev_i16 v62, s57, v62
    v_pk_ashrrev_i16 v63, s57, v63
    v_and_b32 v60, v60, v56
    v_and_b32 v61, v61, v57
    v_and_b32 v62, v62, v58
    v_and_b32 v63, v63, v59
    v_cvt_pk_bf16_f32 v64, v64, v68
    v_cvt_pk_bf16_f32 v65, v65, v69
    v_cvt_pk_bf16_f32 v66, v66, v70
    v_cvt_pk_bf16_f32 v67, v67, v71
    s_nop 1
    v_mfma_f32_16x16x32_bf16 v[112:115], v[64:67], v[60:63], v[112:115]
    ds_read_b128 v[56:59], v3 offset:9072
    ds_read_b128 v[60:63], v3 offset:9264
    ds_write_b64 v4, v[8:9] offset:7840
    s_waitcnt lgkmcnt(3)
    buffer_load_dwordx4 v[36:39], v[12:13], s[8:11], 0 idxen offen
    ds_read_b32 v10, v2 offset:9408
    s_waitcnt vmcnt(1)
    v_mfma_f32_16x16x32_bf16 v[64:67], v[32:35], v[24:27], 0
    v_mfma_f32_16x16x32_bf16 v[68:71], v[32:35], v[28:31], 0
    v_lshlrev_b32 v52, v5, v52
    v_lshlrev_b32 v53, v5, v53
    v_lshlrev_b32 v54, v5, v54
    v_lshlrev_b32 v55, v5, v55
    v_pk_ashrrev_i16 v52, s57, v52
    v_pk_ashrrev_i16 v53, s57, v53
    v_pk_ashrrev_i16 v54, s57, v54
    v_pk_ashrrev_i16 v55, s57, v55
    v_and_b32 v52, v52, v48
    v_and_b32 v53, v53, v49
    v_and_b32 v54, v54, v50
    v_and_b32 v55, v55, v51
    v_cvt_pk_bf16_f32 v64, v64, v68
    v_cvt_pk_bf16_f32 v65, v65, v69
    v_cvt_pk_bf16_f32 v66, v66, v70
    v_cvt_pk_bf16_f32 v67, v67, v71
    s_nop 1
    v_mfma_f32_16x16x32_bf16 v[116:119], v[64:67], v[52:55], v[116:119]
    ds_read_b128 v[48:51], v3 offset:9792
    ds_read_b128 v[52:55], v3 offset:9984
    s_waitcnt lgkmcnt(2)
    buffer_load_dwordx4 v[32:35], v[10:11], s[8:11], 0 idxen offen
    ds_read_b32 v12, v2 offset:9536
    s_waitcnt vmcnt(1)
    v_mfma_f32_16x16x32_bf16 v[64:67], v[36:39], v[24:27], 0
    v_mfma_f32_16x16x32_bf16 v[68:71], v[36:39], v[28:31], 0
    v_lshlrev_b32 v60, v5, v60
    v_lshlrev_b32 v61, v5, v61
    v_lshlrev_b32 v62, v5, v62
    v_lshlrev_b32 v63, v5, v63
    v_pk_ashrrev_i16 v60, s57, v60
    v_pk_ashrrev_i16 v61, s57, v61
    v_pk_ashrrev_i16 v62, s57, v62
    v_pk_ashrrev_i16 v63, s57, v63
    v_and_b32 v60, v60, v56
    v_and_b32 v61, v61, v57
    v_and_b32 v62, v62, v58
    v_and_b32 v63, v63, v59
    v_cvt_pk_bf16_f32 v64, v64, v68
    v_cvt_pk_bf16_f32 v65, v65, v69
    v_cvt_pk_bf16_f32 v66, v66, v70
    v_cvt_pk_bf16_f32 v67, v67, v71
    s_nop 1
    v_mfma_f32_16x16x32_bf16 v[116:119], v[64:67], v[60:63], v[116:119]
    ds_read_b128 v[56:59], v3 offset:9856
    ds_read_b128 v[60:63], v3 offset:10048
    ds_write_b64 v4, v[8:9] offset:8624
    s_waitcnt lgkmcnt(3)
    buffer_load_dwordx4 v[36:39], v[12:13], s[8:11], 0 idxen offen
    ds_read_b32 v10, v2 offset:10192
    s_waitcnt vmcnt(1)
    v_mfma_f32_16x16x32_bf16 v[64:67], v[32:35], v[24:27], 0
    v_mfma_f32_16x16x32_bf16 v[68:71], v[32:35], v[28:31], 0
    v_lshlrev_b32 v52, v5, v52
    v_lshlrev_b32 v53, v5, v53
    v_lshlrev_b32 v54, v5, v54
    v_lshlrev_b32 v55, v5, v55
    v_pk_ashrrev_i16 v52, s57, v52
    v_pk_ashrrev_i16 v53, s57, v53
    v_pk_ashrrev_i16 v54, s57, v54
    v_pk_ashrrev_i16 v55, s57, v55
    v_and_b32 v52, v52, v48
    v_and_b32 v53, v53, v49
    v_and_b32 v54, v54, v50
    v_and_b32 v55, v55, v51
    v_cvt_pk_bf16_f32 v64, v64, v68
    v_cvt_pk_bf16_f32 v65, v65, v69
    v_cvt_pk_bf16_f32 v66, v66, v70
    v_cvt_pk_bf16_f32 v67, v67, v71
    s_nop 1
    v_mfma_f32_16x16x32_bf16 v[120:123], v[64:67], v[52:55], v[120:123]
    ds_read_b128 v[48:51], v3 offset:10576
    ds_read_b128 v[52:55], v3 offset:10768
    s_waitcnt lgkmcnt(2)
    buffer_load_dwordx4 v[32:35], v[10:11], s[8:11], 0 idxen offen
    ds_read_b32 v12, v2 offset:10320
    s_waitcnt vmcnt(1)
    v_mfma_f32_16x16x32_bf16 v[64:67], v[36:39], v[24:27], 0
    v_mfma_f32_16x16x32_bf16 v[68:71], v[36:39], v[28:31], 0
    v_lshlrev_b32 v60, v5, v60
    v_lshlrev_b32 v61, v5, v61
    v_lshlrev_b32 v62, v5, v62
    v_lshlrev_b32 v63, v5, v63
    v_pk_ashrrev_i16 v60, s57, v60
    v_pk_ashrrev_i16 v61, s57, v61
    v_pk_ashrrev_i16 v62, s57, v62
    v_pk_ashrrev_i16 v63, s57, v63
    v_and_b32 v60, v60, v56
    v_and_b32 v61, v61, v57
    v_and_b32 v62, v62, v58
    v_and_b32 v63, v63, v59
    v_cvt_pk_bf16_f32 v64, v64, v68
    v_cvt_pk_bf16_f32 v65, v65, v69
    v_cvt_pk_bf16_f32 v66, v66, v70
    v_cvt_pk_bf16_f32 v67, v67, v71
    s_nop 1
    v_mfma_f32_16x16x32_bf16 v[120:123], v[64:67], v[60:63], v[120:123]
    ds_read_b128 v[56:59], v3 offset:10640
    ds_read_b128 v[60:63], v3 offset:10832
    ds_write_b64 v4, v[8:9] offset:9408
    v_mov_b32 v20, 0
    ds_read_b32 v18, v20 offset:1028
    s_waitcnt lgkmcnt(0)
    v_readfirstlane_b32 s65, v18
    s_add_u32 s66, s20, 1
    s_lshl_b32 s66, s66, 3
    s_cmp_ge_u32 s65, s66
    s_cbranch_scc1 K2_cfilled0
K2_cpoll0:
    s_sleep 1
    ds_read_b32 v18, v20 offset:1028
    s_waitcnt lgkmcnt(0)
    v_readfirstlane_b32 s65, v18
    s_cmp_ge_u32 s65, s66
    s_cbranch_scc0 K2_cpoll0
K2_cfilled0:
    ds_read_b32 v18, v6
    s_waitcnt lgkmcnt(1)
    buffer_load_dwordx4 v[36:39], v[12:13], s[8:11], 0 idxen offen
    ds_read_b32 v10, v7 offset:0
    s_waitcnt vmcnt(1)
    v_mfma_f32_16x16x32_bf16 v[64:67], v[32:35], v[24:27], 0
    v_mfma_f32_16x16x32_bf16 v[68:71], v[32:35], v[28:31], 0
    v_lshlrev_b32 v52, v5, v52
    v_lshlrev_b32 v53, v5, v53
    v_lshlrev_b32 v54, v5, v54
    v_lshlrev_b32 v55, v5, v55
    v_pk_ashrrev_i16 v52, s57, v52
    v_pk_ashrrev_i16 v53, s57, v53
    v_pk_ashrrev_i16 v54, s57, v54
    v_pk_ashrrev_i16 v55, s57, v55
    v_and_b32 v52, v52, v48
    v_and_b32 v53, v53, v49
    v_and_b32 v54, v54, v50
    v_and_b32 v55, v55, v51
    v_cvt_pk_bf16_f32 v64, v64, v68
    v_cvt_pk_bf16_f32 v65, v65, v69
    v_cvt_pk_bf16_f32 v66, v66, v70
    v_cvt_pk_bf16_f32 v67, v67, v71
    s_nop 1
    v_mfma_f32_16x16x32_bf16 v[124:127], v[64:67], v[52:55], v[124:127]
    ds_read_b128 v[48:51], v0 offset:384
    ds_read_b128 v[52:55], v0 offset:576
    s_waitcnt lgkmcnt(0)
    v_cmp_lt_u32 vcc, 64, v18
    s_movk_i32 s48, 96
    v_cmp_lt_u32 s[46:47], s48, v18
    v_mov_b32 v1, v18
    v_mov_b32 v18, 0
    s_and_b32 s64, vcc_lo, 16383
    s_and_b32 s46, s46, 16383
    s_or_b32 s62, s62, s46
    s_mov_b32 exec_lo, 16383
    s_mov_b32 exec_hi, 0
    ds_write_b32 v6, v18
    s_mov_b64 exec, -1
    s_waitcnt lgkmcnt(1)
    buffer_load_dwordx4 v[32:35], v[10:11], s[12:15], 0 idxen offen
    ds_read_b32 v12, v7 offset:128
    s_waitcnt vmcnt(1)
    v_mfma_f32_16x16x32_bf16 v[64:67], v[36:39], v[24:27], 0
    v_mfma_f32_16x16x32_bf16 v[68:71], v[36:39], v[28:31], 0
    v_lshlrev_b32 v60, v5, v60
    v_lshlrev_b32 v61, v5, v61
    v_lshlrev_b32 v62, v5, v62
    v_lshlrev_b32 v63, v5, v63
    v_pk_ashrrev_i16 v60, s57, v60
    v_pk_ashrrev_i16 v61, s57, v61
    v_pk_ashrrev_i16 v62, s57, v62
    v_pk_ashrrev_i16 v63, s57, v63
    v_and_b32 v60, v60, v56
    v_and_b32 v61, v61, v57
    v_and_b32 v62, v62, v58
    v_and_b32 v63, v63, v59
    v_cvt_pk_bf16_f32 v64, v64, v68
    v_cvt_pk_bf16_f32 v65, v65, v69
    v_cvt_pk_bf16_f32 v66, v66, v70
    v_cvt_pk_bf16_f32 v67, v67, v71
    s_nop 1
    v_mfma_f32_16x16x32_bf16 v[124:127], v[64:67], v[60:63], v[124:127]
    ds_read_b128 v[56:59], v0 offset:448
    ds_read_b128 v[60:63], v0 offset:640
    ds_write_b64 v4, v[8:9] offset:10192
    s_mov_b32 s21, s64
    v_add_u32 v2, s55, v2
        v_add_u32 v3, s55, v3
        v_add_u32 v4, s55, v4
        v_subrev_u32 v7, s55, v7
        v_subrev_u32 v0, s55, v0
        v_add_u32 v6, s56, v6
        s_add_u32 s70, s70, s55
        s_sub_u32 s55, 0, s55
        s_sub_u32 s56, 0, s56
        s_mov_b32 s8, s12
        s_mov_b32 s9, s13
        s_mov_b32 s10, s14
        s_add_u32 s12, s12, 2560000
        s_addc_u32 s13, s13, 0
        s_add_u32 s20, s20, 1
        s_cmp_eq_u32 s20, 3
        s_cselect_b32 s14, 80000, s14
        s_waitcnt lgkmcnt(0)
    v_mov_b32 v20, 0
        v_mov_b32 v21, 1
        s_mov_b64 exec, 1
        ds_add_u32 v20, v21 offset:1032
        s_mov_b64 exec, -1
    s_cmp_lt_u32 s20, 4
    s_cbranch_scc1 K2_cloop
    s_waitcnt lgkmcnt(0)
    buffer_load_dwordx4 v[36:39], v[12:13], s[8:11], 0 idxen offen
    ds_read_b32 v10, v2 offset:784
    s_waitcnt vmcnt(1)
    v_mfma_f32_16x16x32_bf16 v[64:67], v[32:35], v[24:27], 0
    v_mfma_f32_16x16x32_bf16 v[68:71], v[32:35], v[28:31], 0
    v_lshlrev_b32 v52, v5, v52
    v_lshlrev_b32 v53, v5, v53
    v_lshlrev_b32 v54, v5, v54
    v_lshlrev_b32 v55, v5, v55
    v_pk_ashrrev_i16 v52, s57, v52
    v_pk_ashrrev_i16 v53, s57, v53
    v_pk_ashrrev_i16 v54, s57, v54
    v_pk_ashrrev_i16 v55, s57, v55
    v_and_b32 v52, v52, v48
    v_and_b32 v53, v53, v49
    v_and_b32 v54, v54, v50
    v_and_b32 v55, v55, v51
    v_cvt_pk_bf16_f32 v64, v64, v68
    v_cvt_pk_bf16_f32 v65, v65, v69
    v_cvt_pk_bf16_f32 v66, v66, v70
    v_cvt_pk_bf16_f32 v67, v67, v71
    s_nop 1
    v_mfma_f32_16x16x32_bf16 v[72:75], v[64:67], v[52:55], v[72:75]
    ds_read_b128 v[48:51], v3 offset:1168
    ds_read_b128 v[52:55], v3 offset:1360
    s_cmp_eq_u32 s21, 0
    s_cbranch_scc1 K2_noxae
    s_ff1_i32_b32 s67, s21
    s_bitset0_b32 s21, s67
    v_readlane_b32 s68, v1, s67
    s_mul_i32 s69, s67, 784
    v_mbcnt_lo_u32_b32 v20, -1, 0
    v_mbcnt_hi_u32_b32 v20, -1, v20
    s_add_u32 s48, s70, s69
    v_add_u32 v21, 64, v20
    s_add_u32 s49, s48, 704
    s_add_u32 s48, s48, 256
    v_cmp_le_u32 vcc, s68, v21
    v_lshl_add_u32 v22, v20, 2, s48
    v_lshl_add_u32 v23, v20, 1, s49
    v_mov_b32 v21, 0
    s_mov_b32 exec_lo, vcc_lo
    s_mov_b32 exec_hi, 0
    ds_write_b32 v22, v8
    ds_write_b16 v23, v21
    s_mov_b64 exec, -1
    v_add_u32 v22, s69, v2
    ds_read_b32 v18, v22 offset:256
    s_waitcnt lgkmcnt(0)
    buffer_load_dwordx4 v[20:23], v[18:19], s[8:11], 0 idxen offen
K2_noxae:
    s_waitcnt lgkmcnt(2)
    buffer_load_dwordx4 v[32:35], v[10:11], s[8:11], 0 idxen offen
    ds_read_b32 v12, v2 offset:912
    s_waitcnt vmcnt(1)
    v_mfma_f32_16x16x32_bf16 v[64:67], v[36:39], v[24:27], 0
    v_mfma_f32_16x16x32_bf16 v[68:71], v[36:39], v[28:31], 0
    v_lshlrev_b32 v60, v5, v60
    v_lshlrev_b32 v61, v5, v61
    v_lshlrev_b32 v62, v5, v62
    v_lshlrev_b32 v63, v5, v63
    v_pk_ashrrev_i16 v60, s57, v60
    v_pk_ashrrev_i16 v61, s57, v61
    v_pk_ashrrev_i16 v62, s57, v62
    v_pk_ashrrev_i16 v63, s57, v63
    v_and_b32 v60, v60, v56
    v_and_b32 v61, v61, v57
    v_and_b32 v62, v62, v58
    v_and_b32 v63, v63, v59
    v_cvt_pk_bf16_f32 v64, v64, v68
    v_cvt_pk_bf16_f32 v65, v65, v69
    v_cvt_pk_bf16_f32 v66, v66, v70
    v_cvt_pk_bf16_f32 v67, v67, v71
    s_nop 1
    v_mfma_f32_16x16x32_bf16 v[72:75], v[64:67], v[60:63], v[72:75]
    ds_read_b128 v[56:59], v3 offset:1232
    ds_read_b128 v[60:63], v3 offset:1424
    ds_write_b64 v4, v[8:9] offset:0
    s_waitcnt lgkmcnt(3)
    buffer_load_dwordx4 v[36:39], v[12:13], s[8:11], 0 idxen offen
    ds_read_b32 v10, v2 offset:1568
    s_waitcnt vmcnt(1)
    v_mfma_f32_16x16x32_bf16 v[64:67], v[32:35], v[24:27], 0
    v_mfma_f32_16x16x32_bf16 v[68:71], v[32:35], v[28:31], 0
    v_lshlrev_b32 v52, v5, v52
    v_lshlrev_b32 v53, v5, v53
    v_lshlrev_b32 v54, v5, v54
    v_lshlrev_b32 v55, v5, v55
    v_pk_ashrrev_i16 v52, s57, v52
    v_pk_ashrrev_i16 v53, s57, v53
    v_pk_ashrrev_i16 v54, s57, v54
    v_pk_ashrrev_i16 v55, s57, v55
    v_and_b32 v52, v52, v48
    v_and_b32 v53, v53, v49
    v_and_b32 v54, v54, v50
    v_and_b32 v55, v55, v51
    v_cvt_pk_bf16_f32 v64, v64, v68
    v_cvt_pk_bf16_f32 v65, v65, v69
    v_cvt_pk_bf16_f32 v66, v66, v70
    v_cvt_pk_bf16_f32 v67, v67, v71
    s_nop 1
    v_mfma_f32_16x16x32_bf16 v[76:79], v[64:67], v[52:55], v[76:79]
    ds_read_b128 v[48:51], v3 offset:1952
    ds_read_b128 v[52:55], v3 offset:2144
    s_waitcnt lgkmcnt(2)
    buffer_load_dwordx4 v[32:35], v[10:11], s[8:11], 0 idxen offen
    ds_read_b32 v12, v2 offset:1696
    s_waitcnt vmcnt(1)
    v_mfma_f32_16x16x32_bf16 v[64:67], v[36:39], v[24:27], 0
    v_mfma_f32_16x16x32_bf16 v[68:71], v[36:39], v[28:31], 0
    v_lshlrev_b32 v60, v5, v60
    v_lshlrev_b32 v61, v5, v61
    v_lshlrev_b32 v62, v5, v62
    v_lshlrev_b32 v63, v5, v63
    v_pk_ashrrev_i16 v60, s57, v60
    v_pk_ashrrev_i16 v61, s57, v61
    v_pk_ashrrev_i16 v62, s57, v62
    v_pk_ashrrev_i16 v63, s57, v63
    v_and_b32 v60, v60, v56
    v_and_b32 v61, v61, v57
    v_and_b32 v62, v62, v58
    v_and_b32 v63, v63, v59
    v_cvt_pk_bf16_f32 v64, v64, v68
    v_cvt_pk_bf16_f32 v65, v65, v69
    v_cvt_pk_bf16_f32 v66, v66, v70
    v_cvt_pk_bf16_f32 v67, v67, v71
    s_nop 1
    v_mfma_f32_16x16x32_bf16 v[76:79], v[64:67], v[60:63], v[76:79]
    ds_read_b128 v[56:59], v3 offset:2016
    ds_read_b128 v[60:63], v3 offset:2208
    ds_write_b64 v4, v[8:9] offset:784
    s_waitcnt lgkmcnt(3)
    buffer_load_dwordx4 v[36:39], v[12:13], s[8:11], 0 idxen offen
    ds_read_b32 v10, v2 offset:2352
    s_waitcnt vmcnt(1)
    v_mfma_f32_16x16x32_bf16 v[64:67], v[32:35], v[24:27], 0
    v_mfma_f32_16x16x32_bf16 v[68:71], v[32:35], v[28:31], 0
    v_lshlrev_b32 v52, v5, v52
    v_lshlrev_b32 v53, v5, v53
    v_lshlrev_b32 v54, v5, v54
    v_lshlrev_b32 v55, v5, v55
    v_pk_ashrrev_i16 v52, s57, v52
    v_pk_ashrrev_i16 v53, s57, v53
    v_pk_ashrrev_i16 v54, s57, v54
    v_pk_ashrrev_i16 v55, s57, v55
    v_and_b32 v52, v52, v48
    v_and_b32 v53, v53, v49
    v_and_b32 v54, v54, v50
    v_and_b32 v55, v55, v51
    v_cvt_pk_bf16_f32 v64, v64, v68
    v_cvt_pk_bf16_f32 v65, v65, v69
    v_cvt_pk_bf16_f32 v66, v66, v70
    v_cvt_pk_bf16_f32 v67, v67, v71
    s_nop 1
    v_mfma_f32_16x16x32_bf16 v[80:83], v[64:67], v[52:55], v[80:83]
    ds_read_b128 v[48:51], v3 offset:2736
    ds_read_b128 v[52:55], v3 offset:2928
    s_waitcnt lgkmcnt(2)
    buffer_load_dwordx4 v[32:35], v[10:11], s[8:11], 0 idxen offen
    ds_read_b32 v12, v2 offset:2480
    s_waitcnt vmcnt(1)
    v_mfma_f32_16x16x32_bf16 v[64:67], v[36:39], v[24:27], 0
    v_mfma_f32_16x16x32_bf16 v[68:71], v[36:39], v[28:31], 0
    v_lshlrev_b32 v60, v5, v60
    v_lshlrev_b32 v61, v5, v61
    v_lshlrev_b32 v62, v5, v62
    v_lshlrev_b32 v63, v5, v63
    v_pk_ashrrev_i16 v60, s57, v60
    v_pk_ashrrev_i16 v61, s57, v61
    v_pk_ashrrev_i16 v62, s57, v62
    v_pk_ashrrev_i16 v63, s57, v63
    v_and_b32 v60, v60, v56
    v_and_b32 v61, v61, v57
    v_and_b32 v62, v62, v58
    v_and_b32 v63, v63, v59
    v_cvt_pk_bf16_f32 v64, v64, v68
    v_cvt_pk_bf16_f32 v65, v65, v69
    v_cvt_pk_bf16_f32 v66, v66, v70
    v_cvt_pk_bf16_f32 v67, v67, v71
    s_nop 1
    v_mfma_f32_16x16x32_bf16 v[80:83], v[64:67], v[60:63], v[80:83]
    ds_read_b128 v[56:59], v3 offset:2800
    ds_read_b128 v[60:63], v3 offset:2992
    ds_write_b64 v4, v[8:9] offset:1568
    s_waitcnt lgkmcnt(3)
    buffer_load_dwordx4 v[36:39], v[12:13], s[8:11], 0 idxen offen
    ds_read_b32 v10, v2 offset:3136
    s_waitcnt vmcnt(1)
    v_mfma_f32_16x16x32_bf16 v[64:67], v[32:35], v[24:27], 0
    v_mfma_f32_16x16x32_bf16 v[68:71], v[32:35], v[28:31], 0
    v_lshlrev_b32 v52, v5, v52
    v_lshlrev_b32 v53, v5, v53
    v_lshlrev_b32 v54, v5, v54
    v_lshlrev_b32 v55, v5, v55
    v_pk_ashrrev_i16 v52, s57, v52
    v_pk_ashrrev_i16 v53, s57, v53
    v_pk_ashrrev_i16 v54, s57, v54
    v_pk_ashrrev_i16 v55, s57, v55
    v_and_b32 v52, v52, v48
    v_and_b32 v53, v53, v49
    v_and_b32 v54, v54, v50
    v_and_b32 v55, v55, v51
    v_cvt_pk_bf16_f32 v64, v64, v68
    v_cvt_pk_bf16_f32 v65, v65, v69
    v_cvt_pk_bf16_f32 v66, v66, v70
    v_cvt_pk_bf16_f32 v67, v67, v71
    s_nop 1
    v_mfma_f32_16x16x32_bf16 v[84:87], v[64:67], v[52:55], v[84:87]
    ds_read_b128 v[48:51], v3 offset:3520
    ds_read_b128 v[52:55], v3 offset:3712
    s_waitcnt lgkmcnt(2)
    buffer_load_dwordx4 v[32:35], v[10:11], s[8:11], 0 idxen offen
    ds_read_b32 v12, v2 offset:3264
    s_waitcnt vmcnt(1)
    v_mfma_f32_16x16x32_bf16 v[64:67], v[36:39], v[24:27], 0
    v_mfma_f32_16x16x32_bf16 v[68:71], v[36:39], v[28:31], 0
    v_lshlrev_b32 v60, v5, v60
    v_lshlrev_b32 v61, v5, v61
    v_lshlrev_b32 v62, v5, v62
    v_lshlrev_b32 v63, v5, v63
    v_pk_ashrrev_i16 v60, s57, v60
    v_pk_ashrrev_i16 v61, s57, v61
    v_pk_ashrrev_i16 v62, s57, v62
    v_pk_ashrrev_i16 v63, s57, v63
    v_and_b32 v60, v60, v56
    v_and_b32 v61, v61, v57
    v_and_b32 v62, v62, v58
    v_and_b32 v63, v63, v59
    v_cvt_pk_bf16_f32 v64, v64, v68
    v_cvt_pk_bf16_f32 v65, v65, v69
    v_cvt_pk_bf16_f32 v66, v66, v70
    v_cvt_pk_bf16_f32 v67, v67, v71
    s_nop 1
    v_mfma_f32_16x16x32_bf16 v[84:87], v[64:67], v[60:63], v[84:87]
    ds_read_b128 v[56:59], v3 offset:3584
    ds_read_b128 v[60:63], v3 offset:3776
    ds_write_b64 v4, v[8:9] offset:2352
    s_cmp_lt_i32 s67, 0
    s_cbranch_scc1 K2_noxbe
    v_mfma_f32_16x16x32_bf16 v[64:67], v[20:23], v[24:27], 0
    v_mfma_f32_16x16x32_bf16 v[68:71], v[20:23], v[28:31], 0
    v_add_u32 v18, s69, v3
    s_nop 7
    v_cvt_pk_bf16_f32 v64, v64, v68
    v_cvt_pk_bf16_f32 v65, v65, v69
    v_cvt_pk_bf16_f32 v66, v66, v70
    v_cvt_pk_bf16_f32 v67, v67, v71
    ds_read_b128 v[20:23], v18 offset:512
    ds_read_b128 v[68:71], v18 offset:704
    s_waitcnt lgkmcnt(0)
    v_lshlrev_b32 v68, v5, v68
    v_lshlrev_b32 v69, v5, v69
    v_lshlrev_b32 v70, v5, v70
    v_lshlrev_b32 v71, v5, v71
    v_pk_ashrrev_i16 v68, s57, v68
    v_pk_ashrrev_i16 v69, s57, v69
    v_pk_ashrrev_i16 v70, s57, v70
    v_pk_ashrrev_i16 v71, s57, v71
    v_and_b32 v68, v68, v20
    v_and_b32 v69, v69, v21
    v_and_b32 v70, v70, v22
    v_and_b32 v71, v71, v23
    s_cmp_eq_u32 s67, 0
    s_cbranch_scc0 K2_xjae_0
    v_mfma_f32_16x16x32_bf16 v[72:75], v[64:67], v[68:71], v[72:75]
    s_branch K2_xdoneae
K2_xjae_0:
    s_cmp_eq_u32 s67, 1
    s_cbranch_scc0 K2_xjae_1
    v_mfma_f32_16x16x32_bf16 v[76:79], v[64:67], v[68:71], v[76:79]
    s_branch K2_xdoneae
K2_xjae_1:
    s_cmp_eq_u32 s67, 2
    s_cbranch_scc0 K2_xjae_2
    v_mfma_f32_16x16x32_bf16 v[80:83], v[64:67], v[68:71], v[80:83]
    s_branch K2_xdoneae
K2_xjae_2:
    s_cmp_eq_u32 s67, 3
    s_cbranch_scc0 K2_xjae_3
    v_mfma_f32_16x16x32_bf16 v[84:87], v[64:67], v[68:71], v[84:87]
    s_branch K2_xdoneae
K2_xjae_3:
    s_cmp_eq_u32 s67, 4
    s_cbranch_scc0 K2_xjae_4
    v_mfma_f32_16x16x32_bf16 v[88:91], v[64:67], v[68:71], v[88:91]
    s_branch K2_xdoneae
K2_xjae_4:
    s_cmp_eq_u32 s67, 5
    s_cbranch_scc0 K2_xjae_5
    v_mfma_f32_16x16x32_bf16 v[92:95], v[64:67], v[68:71], v[92:95]
    s_branch K2_xdoneae
K2_xjae_5:
    s_cmp_eq_u32 s67, 6
    s_cbranch_scc0 K2_xjae_6
    v_mfma_f32_16x16x32_bf16 v[96:99], v[64:67], v[68:71], v[96:99]
    s_branch K2_xdoneae
K2_xjae_6:
    s_cmp_eq_u32 s67, 7
    s_cbranch_scc0 K2_xjae_7
    v_mfma_f32_16x16x32_bf16 v[100:103], v[64:67], v[68:71], v[100:103]
    s_branch K2_xdoneae
K2_xjae_7:
    s_cmp_eq_u32 s67, 8
    s_cbranch_scc0 K2_xjae_8
    v_mfma_f32_16x16x32_bf16 v[104:107], v[64:67], v[68:71], v[104:107]
    s_branch K2_xdoneae
K2_xjae_8:
    s_cmp_eq_u32 s67, 9
    s_cbranch_scc0 K2_xjae_9
    v_mfma_f32_16x16x32_bf16 v[108:111], v[64:67], v[68:71], v[108:111]
    s_branch K2_xdoneae
K2_xjae_9:
    s_cmp_eq_u32 s67, 10
    s_cbranch_scc0 K2_xjae_10
    v_mfma_f32_16x16x32_bf16 v[112:115], v[64:67], v[68:71], v[112:115]
    s_branch K2_xdoneae
K2_xjae_10:
    s_cmp_eq_u32 s67, 11
    s_cbranch_scc0 K2_xjae_11
    v_mfma_f32_16x16x32_bf16 v[116:119], v[64:67], v[68:71], v[116:119]
    s_branch K2_xdoneae
K2_xjae_11:
    s_cmp_eq_u32 s67, 12
    s_cbranch_scc0 K2_xjae_12
    v_mfma_f32_16x16x32_bf16 v[120:123], v[64:67], v[68:71], v[120:123]
    s_branch K2_xdoneae
K2_xjae_12:
    s_cmp_eq_u32 s67, 13
    s_cbranch_scc0 K2_xjae_13
    v_mfma_f32_16x16x32_bf16 v[124:127], v[64:67], v[68:71], v[124:127]
    s_branch K2_xdoneae
K2_xjae_13:
K2_xdoneae:
    s_mov_b32 s67, -1
K2_noxbe:
    s_waitcnt lgkmcnt(3)
    buffer_load_dwordx4 v[36:39], v[12:13], s[8:11], 0 idxen offen
    ds_read_b32 v10, v2 offset:3920
    s_waitcnt vmcnt(1)
    v_mfma_f32_16x16x32_bf16 v[64:67], v[32:35], v[24:27], 0
    v_mfma_f32_16x16x32_bf16 v[68:71], v[32:35], v[28:31], 0
    v_lshlrev_b32 v52, v5, v52
    v_lshlrev_b32 v53, v5, v53
    v_lshlrev_b32 v54, v5, v54
    v_lshlrev_b32 v55, v5, v55
    v_pk_ashrrev_i16 v52, s57, v52
    v_pk_ashrrev_i16 v53, s57, v53
    v_pk_ashrrev_i16 v54, s57, v54
    v_pk_ashrrev_i16 v55, s57, v55
    v_and_b32 v52, v52, v48
    v_and_b32 v53, v53, v49
    v_and_b32 v54, v54, v50
    v_and_b32 v55, v55, v51
    v_cvt_pk_bf16_f32 v64, v64, v68
    v_cvt_pk_bf16_f32 v65, v65, v69
    v_cvt_pk_bf16_f32 v66, v66, v70
    v_cvt_pk_bf16_f32 v67, v67, v71
    s_nop 1
    v_mfma_f32_16x16x32_bf16 v[88:91], v[64:67], v[52:55], v[88:91]
    ds_read_b128 v[48:51], v3 offset:4304
    ds_read_b128 v[52:55], v3 offset:4496
    s_waitcnt lgkmcnt(2)
    buffer_load_dwordx4 v[32:35], v[10:11], s[8:11], 0 idxen offen
    ds_read_b32 v12, v2 offset:4048
    s_waitcnt vmcnt(1)
    v_mfma_f32_16x16x32_bf16 v[64:67], v[36:39], v[24:27], 0
    v_mfma_f32_16x16x32_bf16 v[68:71], v[36:39], v[28:31], 0
    v_lshlrev_b32 v60, v5, v60
    v_lshlrev_b32 v61, v5, v61
    v_lshlrev_b32 v62, v5, v62
    v_lshlrev_b32 v63, v5, v63
    v_pk_ashrrev_i16 v60, s57, v60
    v_pk_ashrrev_i16 v61, s57, v61
    v_pk_ashrrev_i16 v62, s57, v62
    v_pk_ashrrev_i16 v63, s57, v63
    v_and_b32 v60, v60, v56
    v_and_b32 v61, v61, v57
    v_and_b32 v62, v62, v58
    v_and_b32 v63, v63, v59
    v_cvt_pk_bf16_f32 v64, v64, v68
    v_cvt_pk_bf16_f32 v65, v65, v69
    v_cvt_pk_bf16_f32 v66, v66, v70
    v_cvt_pk_bf16_f32 v67, v67, v71
    s_nop 1
    v_mfma_f32_16x16x32_bf16 v[88:91], v[64:67], v[60:63], v[88:91]
    ds_read_b128 v[56:59], v3 offset:4368
    ds_read_b128 v[60:63], v3 offset:4560
    ds_write_b64 v4, v[8:9] offset:3136
    s_waitcnt lgkmcnt(3)
    buffer_load_dwordx4 v[36:39], v[12:13], s[8:11], 0 idxen offen
    ds_read_b32 v10, v2 offset:4704
    s_waitcnt vmcnt(1)
    v_mfma_f32_16x16x32_bf16 v[64:67], v[32:35], v[24:27], 0
    v_mfma_f32_16x16x32_bf16 v[68:71], v[32:35], v[28:31], 0
    v_lshlrev_b32 v52, v5, v52
    v_lshlrev_b32 v53, v5, v53
    v_lshlrev_b32 v54, v5, v54
    v_lshlrev_b32 v55, v5, v55
    v_pk_ashrrev_i16 v52, s57, v52
    v_pk_ashrrev_i16 v53, s57, v53
    v_pk_ashrrev_i16 v54, s57, v54
    v_pk_ashrrev_i16 v55, s57, v55
    v_and_b32 v52, v52, v48
    v_and_b32 v53, v53, v49
    v_and_b32 v54, v54, v50
    v_and_b32 v55, v55, v51
    v_cvt_pk_bf16_f32 v64, v64, v68
    v_cvt_pk_bf16_f32 v65, v65, v69
    v_cvt_pk_bf16_f32 v66, v66, v70
    v_cvt_pk_bf16_f32 v67, v67, v71
    s_nop 1
    v_mfma_f32_16x16x32_bf16 v[92:95], v[64:67], v[52:55], v[92:95]
    ds_read_b128 v[48:51], v3 offset:5088
    ds_read_b128 v[52:55], v3 offset:5280
    s_waitcnt lgkmcnt(2)
    buffer_load_dwordx4 v[32:35], v[10:11], s[8:11], 0 idxen offen
    ds_read_b32 v12, v2 offset:4832
    s_waitcnt vmcnt(1)
    v_mfma_f32_16x16x32_bf16 v[64:67], v[36:39], v[24:27], 0
    v_mfma_f32_16x16x32_bf16 v[68:71], v[36:39], v[28:31], 0
    v_lshlrev_b32 v60, v5, v60
    v_lshlrev_b32 v61, v5, v61
    v_lshlrev_b32 v62, v5, v62
    v_lshlrev_b32 v63, v5, v63
    v_pk_ashrrev_i16 v60, s57, v60
    v_pk_ashrrev_i16 v61, s57, v61
    v_pk_ashrrev_i16 v62, s57, v62
    v_pk_ashrrev_i16 v63, s57, v63
    v_and_b32 v60, v60, v56
    v_and_b32 v61, v61, v57
    v_and_b32 v62, v62, v58
    v_and_b32 v63, v63, v59
    v_cvt_pk_bf16_f32 v64, v64, v68
    v_cvt_pk_bf16_f32 v65, v65, v69
    v_cvt_pk_bf16_f32 v66, v66, v70
    v_cvt_pk_bf16_f32 v67, v67, v71
    s_nop 1
    v_mfma_f32_16x16x32_bf16 v[92:95], v[64:67], v[60:63], v[92:95]
    ds_read_b128 v[56:59], v3 offset:5152
    ds_read_b128 v[60:63], v3 offset:5344
    ds_write_b64 v4, v[8:9] offset:3920
    s_waitcnt lgkmcnt(3)
    buffer_load_dwordx4 v[36:39], v[12:13], s[8:11], 0 idxen offen
    ds_read_b32 v10, v2 offset:5488
    s_waitcnt vmcnt(1)
    v_mfma_f32_16x16x32_bf16 v[64:67], v[32:35], v[24:27], 0
    v_mfma_f32_16x16x32_bf16 v[68:71], v[32:35], v[28:31], 0
    v_lshlrev_b32 v52, v5, v52
    v_lshlrev_b32 v53, v5, v53
    v_lshlrev_b32 v54, v5, v54
    v_lshlrev_b32 v55, v5, v55
    v_pk_ashrrev_i16 v52, s57, v52
    v_pk_ashrrev_i16 v53, s57, v53
    v_pk_ashrrev_i16 v54, s57, v54
    v_pk_ashrrev_i16 v55, s57, v55
    v_and_b32 v52, v52, v48
    v_and_b32 v53, v53, v49
    v_and_b32 v54, v54, v50
    v_and_b32 v55, v55, v51
    v_cvt_pk_bf16_f32 v64, v64, v68
    v_cvt_pk_bf16_f32 v65, v65, v69
    v_cvt_pk_bf16_f32 v66, v66, v70
    v_cvt_pk_bf16_f32 v67, v67, v71
    s_nop 1
    v_mfma_f32_16x16x32_bf16 v[96:99], v[64:67], v[52:55], v[96:99]
    ds_read_b128 v[48:51], v3 offset:5872
    ds_read_b128 v[52:55], v3 offset:6064
    s_waitcnt lgkmcnt(2)
    buffer_load_dwordx4 v[32:35], v[10:11], s[8:11], 0 idxen offen
    ds_read_b32 v12, v2 offset:5616
    s_waitcnt vmcnt(1)
    v_mfma_f32_16x16x32_bf16 v[64:67], v[36:39], v[24:27], 0
    v_mfma_f32_16x16x32_bf16 v[68:71], v[36:39], v[28:31], 0
    v_lshlrev_b32 v60, v5, v60
    v_lshlrev_b32 v61, v5, v61
    v_lshlrev_b32 v62, v5, v62
    v_lshlrev_b32 v63, v5, v63
    v_pk_ashrrev_i16 v60, s57, v60
    v_pk_ashrrev_i16 v61, s57, v61
    v_pk_ashrrev_i16 v62, s57, v62
    v_pk_ashrrev_i16 v63, s57, v63
    v_and_b32 v60, v60, v56
    v_and_b32 v61, v61, v57
    v_and_b32 v62, v62, v58
    v_and_b32 v63, v63, v59
    v_cvt_pk_bf16_f32 v64, v64, v68
    v_cvt_pk_bf16_f32 v65, v65, v69
    v_cvt_pk_bf16_f32 v66, v66, v70
    v_cvt_pk_bf16_f32 v67, v67, v71
    s_nop 1
    v_mfma_f32_16x16x32_bf16 v[96:99], v[64:67], v[60:63], v[96:99]
    ds_read_b128 v[56:59], v3 offset:5936
    ds_read_b128 v[60:63], v3 offset:6128
    ds_write_b64 v4, v[8:9] offset:4704
    s_waitcnt lgkmcnt(3)
    buffer_load_dwordx4 v[36:39], v[12:13], s[8:11], 0 idxen offen
    ds_read_b32 v10, v2 offset:6272
    s_waitcnt vmcnt(1)
    v_mfma_f32_16x16x32_bf16 v[64:67], v[32:35], v[24:27], 0
    v_mfma_f32_16x16x32_bf16 v[68:71], v[32:35], v[28:31], 0
    v_lshlrev_b32 v52, v5, v52
    v_lshlrev_b32 v53, v5, v53
    v_lshlrev_b32 v54, v5, v54
    v_lshlrev_b32 v55, v5, v55
    v_pk_ashrrev_i16 v52, s57, v52
    v_pk_ashrrev_i16 v53, s57, v53
    v_pk_ashrrev_i16 v54, s57, v54
    v_pk_ashrrev_i16 v55, s57, v55
    v_and_b32 v52, v52, v48
    v_and_b32 v53, v53, v49
    v_and_b32 v54, v54, v50
    v_and_b32 v55, v55, v51
    v_cvt_pk_bf16_f32 v64, v64, v68
    v_cvt_pk_bf16_f32 v65, v65, v69
    v_cvt_pk_bf16_f32 v66, v66, v70
    v_cvt_pk_bf16_f32 v67, v67, v71
    s_nop 1
    v_mfma_f32_16x16x32_bf16 v[100:103], v[64:67], v[52:55], v[100:103]
    ds_read_b128 v[48:51], v3 offset:6656
    ds_read_b128 v[52:55], v3 offset:6848
    s_waitcnt lgkmcnt(2)
    buffer_load_dwordx4 v[32:35], v[10:11], s[8:11], 0 idxen offen
    ds_read_b32 v12, v2 offset:6400
    s_waitcnt vmcnt(1)
    v_mfma_f32_16x16x32_bf16 v[64:67], v[36:39], v[24:27], 0
    v_mfma_f32_16x16x32_bf16 v[68:71], v[36:39], v[28:31], 0
    v_lshlrev_b32 v60, v5, v60
    v_lshlrev_b32 v61, v5, v61
    v_lshlrev_b32 v62, v5, v62
    v_lshlrev_b32 v63, v5, v63
    v_pk_ashrrev_i16 v60, s57, v60
    v_pk_ashrrev_i16 v61, s57, v61
    v_pk_ashrrev_i16 v62, s57, v62
    v_pk_ashrrev_i16 v63, s57, v63
    v_and_b32 v60, v60, v56
    v_and_b32 v61, v61, v57
    v_and_b32 v62, v62, v58
    v_and_b32 v63, v63, v59
    v_cvt_pk_bf16_f32 v64, v64, v68
    v_cvt_pk_bf16_f32 v65, v65, v69
    v_cvt_pk_bf16_f32 v66, v66, v70
    v_cvt_pk_bf16_f32 v67, v67, v71
    s_nop 1
    v_mfma_f32_16x16x32_bf16 v[100:103], v[64:67], v[60:63], v[100:103]
    ds_read_b128 v[56:59], v3 offset:6720
    ds_read_b128 v[60:63], v3 offset:6912
    ds_write_b64 v4, v[8:9] offset:5488
    s_waitcnt lgkmcnt(3)
    buffer_load_dwordx4 v[36:39], v[12:13], s[8:11], 0 idxen offen
    ds_read_b32 v10, v2 offset:7056
    s_waitcnt vmcnt(1)
    v_mfma_f32_16x16x32_bf16 v[64:67], v[32:35], v[24:27], 0
    v_mfma_f32_16x16x32_bf16 v[68:71], v[32:35], v[28:31], 0
    v_lshlrev_b32 v52, v5, v52
    v_lshlrev_b32 v53, v5, v53
    v_lshlrev_b32 v54, v5, v54
    v_lshlrev_b32 v55, v5, v55
    v_pk_ashrrev_i16 v52, s57, v52
    v_pk_ashrrev_i16 v53, s57, v53
    v_pk_ashrrev_i16 v54, s57, v54
    v_pk_ashrrev_i16 v55, s57, v55
    v_and_b32 v52, v52, v48
    v_and_b32 v53, v53, v49
    v_and_b32 v54, v54, v50
    v_and_b32 v55, v55, v51
    v_cvt_pk_bf16_f32 v64, v64, v68
    v_cvt_pk_bf16_f32 v65, v65, v69
    v_cvt_pk_bf16_f32 v66, v66, v70
    v_cvt_pk_bf16_f32 v67, v67, v71
    s_nop 1
    v_mfma_f32_16x16x32_bf16 v[104:107], v[64:67], v[52:55], v[104:107]
    ds_read_b128 v[48:51], v3 offset:7440
    ds_read_b128 v[52:55], v3 offset:7632
    s_waitcnt lgkmcnt(2)
    buffer_load_dwordx4 v[32:35], v[10:11], s[8:11], 0 idxen offen
    ds_read_b32 v12, v2 offset:7184
    s_waitcnt vmcnt(1)
    v_mfma_f32_16x16x32_bf16 v[64:67], v[36:39], v[24:27], 0
    v_mfma_f32_16x16x32_bf16 v[68:71], v[36:39], v[28:31], 0
    v_lshlrev_b32 v60, v5, v60
    v_lshlrev_b32 v61, v5, v61
    v_lshlrev_b32 v62, v5, v62
    v_lshlrev_b32 v63, v5, v63
    v_pk_ashrrev_i16 v60, s57, v60
    v_pk_ashrrev_i16 v61, s57, v61
    v_pk_ashrrev_i16 v62, s57, v62
    v_pk_ashrrev_i16 v63, s57, v63
    v_and_b32 v60, v60, v56
    v_and_b32 v61, v61, v57
    v_and_b32 v62, v62, v58
    v_and_b32 v63, v63, v59
    v_cvt_pk_bf16_f32 v64, v64, v68
    v_cvt_pk_bf16_f32 v65, v65, v69
    v_cvt_pk_bf16_f32 v66, v66, v70
    v_cvt_pk_bf16_f32 v67, v67, v71
    s_nop 1
    v_mfma_f32_16x16x32_bf16 v[104:107], v[64:67], v[60:63], v[104:107]
    ds_read_b128 v[56:59], v3 offset:7504
    ds_read_b128 v[60:63], v3 offset:7696
    ds_write_b64 v4, v[8:9] offset:6272
K2_xloope:
    s_cmp_eq_u32 s21, 0
    s_cbranch_scc1 K2_noxce
    s_ff1_i32_b32 s67, s21
    s_bitset0_b32 s21, s67
    v_readlane_b32 s68, v1, s67
    s_mul_i32 s69, s67, 784
    v_mbcnt_lo_u32_b32 v20, -1, 0
    v_mbcnt_hi_u32_b32 v20, -1, v20
    s_add_u32 s48, s70, s69
    v_add_u32 v21, 64, v20
    s_add_u32 s49, s48, 704
    s_add_u32 s48, s48, 256
    v_cmp_le_u32 vcc, s68, v21
    v_lshl_add_u32 v22, v20, 2, s48
    v_lshl_add_u32 v23, v20, 1, s49
    v_mov_b32 v21, 0
    s_mov_b32 exec_lo, vcc_lo
    s_mov_b32 exec_hi, 0
    ds_write_b32 v22, v8
    ds_write_b16 v23, v21
    s_mov_b64 exec, -1
    v_add_u32 v22, s69, v2
    ds_read_b32 v18, v22 offset:256
    s_waitcnt lgkmcnt(0)
    buffer_load_dwordx4 v[20:23], v[18:19], s[8:11], 0 idxen offen
    s_waitcnt vmcnt(0)
    v_mfma_f32_16x16x32_bf16 v[64:67], v[20:23], v[24:27], 0
    v_mfma_f32_16x16x32_bf16 v[68:71], v[20:23], v[28:31], 0
    v_add_u32 v18, s69, v3
    s_nop 7
    v_cvt_pk_bf16_f32 v64, v64, v68
    v_cvt_pk_bf16_f32 v65, v65, v69
    v_cvt_pk_bf16_f32 v66, v66, v70
    v_cvt_pk_bf16_f32 v67, v67, v71
    ds_read_b128 v[20:23], v18 offset:512
    ds_read_b128 v[68:71], v18 offset:704
    s_waitcnt lgkmcnt(0)
    v_lshlrev_b32 v68, v5, v68
    v_lshlrev_b32 v69, v5, v69
    v_lshlrev_b32 v70, v5, v70
    v_lshlrev_b32 v71, v5, v71
    v_pk_ashrrev_i16 v68, s57, v68
    v_pk_ashrrev_i16 v69, s57, v69
    v_pk_ashrrev_i16 v70, s57, v70
    v_pk_ashrrev_i16 v71, s57, v71
    v_and_b32 v68, v68, v20
    v_and_b32 v69, v69, v21
    v_and_b32 v70, v70, v22
    v_and_b32 v71, v71, v23
    s_cmp_eq_u32 s67, 0
    s_cbranch_scc0 K2_xjce_0
    v_mfma_f32_16x16x32_bf16 v[72:75], v[64:67], v[68:71], v[72:75]
    s_branch K2_xdonece
K2_xjce_0:
    s_cmp_eq_u32 s67, 1
    s_cbranch_scc0 K2_xjce_1
    v_mfma_f32_16x16x32_bf16 v[76:79], v[64:67], v[68:71], v[76:79]
    s_branch K2_xdonece
K2_xjce_1:
    s_cmp_eq_u32 s67, 2
    s_cbranch_scc0 K2_xjce_2
    v_mfma_f32_16x16x32_bf16 v[80:83], v[64:67], v[68:71], v[80:83]
    s_branch K2_xdonece
K2_xjce_2:
    s_cmp_eq_u32 s67, 3
    s_cbranch_scc0 K2_xjce_3
    v_mfma_f32_16x16x32_bf16 v[84:87], v[64:67], v[68:71], v[84:87]
    s_branch K2_xdonece
K2_xjce_3:
    s_cmp_eq_u32 s67, 4
    s_cbranch_scc0 K2_xjce_4
    v_mfma_f32_16x16x32_bf16 v[88:91], v[64:67], v[68:71], v[88:91]
    s_branch K2_xdonece
K2_xjce_4:
    s_cmp_eq_u32 s67, 5
    s_cbranch_scc0 K2_xjce_5
    v_mfma_f32_16x16x32_bf16 v[92:95], v[64:67], v[68:71], v[92:95]
    s_branch K2_xdonece
K2_xjce_5:
    s_cmp_eq_u32 s67, 6
    s_cbranch_scc0 K2_xjce_6
    v_mfma_f32_16x16x32_bf16 v[96:99], v[64:67], v[68:71], v[96:99]
    s_branch K2_xdonece
K2_xjce_6:
    s_cmp_eq_u32 s67, 7
    s_cbranch_scc0 K2_xjce_7
    v_mfma_f32_16x16x32_bf16 v[100:103], v[64:67], v[68:71], v[100:103]
    s_branch K2_xdonece
K2_xjce_7:
    s_cmp_eq_u32 s67, 8
    s_cbranch_scc0 K2_xjce_8
    v_mfma_f32_16x16x32_bf16 v[104:107], v[64:67], v[68:71], v[104:107]
    s_branch K2_xdonece
K2_xjce_8:
    s_cmp_eq_u32 s67, 9
    s_cbranch_scc0 K2_xjce_9
    v_mfma_f32_16x16x32_bf16 v[108:111], v[64:67], v[68:71], v[108:111]
    s_branch K2_xdonece
K2_xjce_9:
    s_cmp_eq_u32 s67, 10
    s_cbranch_scc0 K2_xjce_10
    v_mfma_f32_16x16x32_bf16 v[112:115], v[64:67], v[68:71], v[112:115]
    s_branch K2_xdonece
K2_xjce_10:
    s_cmp_eq_u32 s67, 11
    s_cbranch_scc0 K2_xjce_11
    v_mfma_f32_16x16x32_bf16 v[116:119], v[64:67], v[68:71], v[116:119]
    s_branch K2_xdonece
K2_xjce_11:
    s_cmp_eq_u32 s67, 12
    s_cbranch_scc0 K2_xjce_12
    v_mfma_f32_16x16x32_bf16 v[120:123], v[64:67], v[68:71], v[120:123]
    s_branch K2_xdonece
K2_xjce_12:
    s_cmp_eq_u32 s67, 13
    s_cbranch_scc0 K2_xjce_13
    v_mfma_f32_16x16x32_bf16 v[124:127], v[64:67], v[68:71], v[124:127]
    s_branch K2_xdonece
K2_xjce_13:
K2_xdonece:
    s_mov_b32 s67, -1
    s_branch K2_xloope
K2_noxce:
    s_waitcnt lgkmcnt(3)
    buffer_load_dwordx4 v[36:39], v[12:13], s[8:11], 0 idxen offen
    ds_read_b32 v10, v2 offset:7840
    s_waitcnt vmcnt(1)
    v_mfma_f32_16x16x32_bf16 v[64:67], v[32:35], v[24:27], 0
    v_mfma_f32_16x16x32_bf16 v[68:71], v[32:35], v[28:31], 0
    v_lshlrev_b32 v52, v5, v52
    v_lshlrev_b32 v53, v5, v53
    v_lshlrev_b32 v54, v5, v54
    v_lshlrev_b32 v55, v5, v55
    v_pk_ashrrev_i16 v52, s57, v52
    v_pk_ashrrev_i16 v53, s57, v53
    v_pk_ashrrev_i16 v54, s57, v54
    v_pk_ashrrev_i16 v55, s57, v55
    v_and_b32 v52, v52, v48
    v_and_b32 v53, v53, v49
    v_and_b32 v54, v54, v50
    v_and_b32 v55, v55, v51
    v_cvt_pk_bf16_f32 v64, v64, v68
    v_cvt_pk_bf16_f32 v65, v65, v69
    v_cvt_pk_bf16_f32 v66, v66, v70
    v_cvt_pk_bf16_f32 v67, v67, v71
    s_nop 1
    v_mfma_f32_16x16x32_bf16 v[108:111], v[64:67], v[52:55], v[108:111]
    ds_read_b128 v[48:51], v3 offset:8224
    ds_read_b128 v[52:55], v3 offset:8416
    s_waitcnt lgkmcnt(2)
    buffer_load_dwordx4 v[32:35], v[10:11], s[8:11], 0 idxen offen
    ds_read_b32 v12, v2 offset:7968
    s_waitcnt vmcnt(1)
    v_mfma_f32_16x16x32_bf16 v[64:67], v[36:39], v[24:27], 0
    v_mfma_f32_16x16x32_bf16 v[68:71], v[36:39], v[28:31], 0
    v_lshlrev_b32 v60, v5, v60
    v_lshlrev_b32 v61, v5, v61
    v_lshlrev_b32 v62, v5, v62
    v_lshlrev_b32 v63, v5, v63
    v_pk_ashrrev_i16 v60, s57, v60
    v_pk_ashrrev_i16 v61, s57, v61
    v_pk_ashrrev_i16 v62, s57, v62
    v_pk_ashrrev_i16 v63, s57, v63
    v_and_b32 v60, v60, v56
    v_and_b32 v61, v61, v57
    v_and_b32 v62, v62, v58
    v_and_b32 v63, v63, v59
    v_cvt_pk_bf16_f32 v64, v64, v68
    v_cvt_pk_bf16_f32 v65, v65, v69
    v_cvt_pk_bf16_f32 v66, v66, v70
    v_cvt_pk_bf16_f32 v67, v67, v71
    s_nop 1
    v_mfma_f32_16x16x32_bf16 v[108:111], v[64:67], v[60:63], v[108:111]
    ds_read_b128 v[56:59], v3 offset:8288
    ds_read_b128 v[60:63], v3 offset:8480
    ds_write_b64 v4, v[8:9] offset:7056
    s_waitcnt lgkmcnt(3)
    buffer_load_dwordx4 v[36:39], v[12:13], s[8:11], 0 idxen offen
    ds_read_b32 v10, v2 offset:8624
    s_waitcnt vmcnt(1)
    v_mfma_f32_16x16x32_bf16 v[64:67], v[32:35], v[24:27], 0
    v_mfma_f32_16x16x32_bf16 v[68:71], v[32:35], v[28:31], 0
    v_lshlrev_b32 v52, v5, v52
    v_lshlrev_b32 v53, v5, v53
    v_lshlrev_b32 v54, v5, v54
    v_lshlrev_b32 v55, v5, v55
    v_pk_ashrrev_i16 v52, s57, v52
    v_pk_ashrrev_i16 v53, s57, v53
    v_pk_ashrrev_i16 v54, s57, v54
    v_pk_ashrrev_i16 v55, s57, v55
    v_and_b32 v52, v52, v48
    v_and_b32 v53, v53, v49
    v_and_b32 v54, v54, v50
    v_and_b32 v55, v55, v51
    v_cvt_pk_bf16_f32 v64, v64, v68
    v_cvt_pk_bf16_f32 v65, v65, v69
    v_cvt_pk_bf16_f32 v66, v66, v70
    v_cvt_pk_bf16_f32 v67, v67, v71
    s_nop 1
    v_mfma_f32_16x16x32_bf16 v[112:115], v[64:67], v[52:55], v[112:115]
    ds_read_b128 v[48:51], v3 offset:9008
    ds_read_b128 v[52:55], v3 offset:9200
    s_waitcnt lgkmcnt(2)
    buffer_load_dwordx4 v[32:35], v[10:11], s[8:11], 0 idxen offen
    ds_read_b32 v12, v2 offset:8752
    s_waitcnt vmcnt(1)
    v_mfma_f32_16x16x32_bf16 v[64:67], v[36:39], v[24:27], 0
    v_mfma_f32_16x16x32_bf16 v[68:71], v[36:39], v[28:31], 0
    v_lshlrev_b32 v60, v5, v60
    v_lshlrev_b32 v61, v5, v61
    v_lshlrev_b32 v62, v5, v62
    v_lshlrev_b32 v63, v5, v63
    v_pk_ashrrev_i16 v60, s57, v60
    v_pk_ashrrev_i16 v61, s57, v61
    v_pk_ashrrev_i16 v62, s57, v62
    v_pk_ashrrev_i16 v63, s57, v63
    v_and_b32 v60, v60, v56
    v_and_b32 v61, v61, v57
    v_and_b32 v62, v62, v58
    v_and_b32 v63, v63, v59
    v_cvt_pk_bf16_f32 v64, v64, v68
    v_cvt_pk_bf16_f32 v65, v65, v69
    v_cvt_pk_bf16_f32 v66, v66, v70
    v_cvt_pk_bf16_f32 v67, v67, v71
    s_nop 1
    v_mfma_f32_16x16x32_bf16 v[112:115], v[64:67], v[60:63], v[112:115]
    ds_read_b128 v[56:59], v3 offset:9072
    ds_read_b128 v[60:63], v3 offset:9264
    ds_write_b64 v4, v[8:9] offset:7840
    s_waitcnt lgkmcnt(3)
    buffer_load_dwordx4 v[36:39], v[12:13], s[8:11], 0 idxen offen
    ds_read_b32 v10, v2 offset:9408
    s_waitcnt vmcnt(1)
    v_mfma_f32_16x16x32_bf16 v[64:67], v[32:35], v[24:27], 0
    v_mfma_f32_16x16x32_bf16 v[68:71], v[32:35], v[28:31], 0
    v_lshlrev_b32 v52, v5, v52
    v_lshlrev_b32 v53, v5, v53
    v_lshlrev_b32 v54, v5, v54
    v_lshlrev_b32 v55, v5, v55
    v_pk_ashrrev_i16 v52, s57, v52
    v_pk_ashrrev_i16 v53, s57, v53
    v_pk_ashrrev_i16 v54, s57, v54
    v_pk_ashrrev_i16 v55, s57, v55
    v_and_b32 v52, v52, v48
    v_and_b32 v53, v53, v49
    v_and_b32 v54, v54, v50
    v_and_b32 v55, v55, v51
    v_cvt_pk_bf16_f32 v64, v64, v68
    v_cvt_pk_bf16_f32 v65, v65, v69
    v_cvt_pk_bf16_f32 v66, v66, v70
    v_cvt_pk_bf16_f32 v67, v67, v71
    s_nop 1
    v_mfma_f32_16x16x32_bf16 v[116:119], v[64:67], v[52:55], v[116:119]
    ds_read_b128 v[48:51], v3 offset:9792
    ds_read_b128 v[52:55], v3 offset:9984
    s_waitcnt lgkmcnt(2)
    buffer_load_dwordx4 v[32:35], v[10:11], s[8:11], 0 idxen offen
    ds_read_b32 v12, v2 offset:9536
    s_waitcnt vmcnt(1)
    v_mfma_f32_16x16x32_bf16 v[64:67], v[36:39], v[24:27], 0
    v_mfma_f32_16x16x32_bf16 v[68:71], v[36:39], v[28:31], 0
    v_lshlrev_b32 v60, v5, v60
    v_lshlrev_b32 v61, v5, v61
    v_lshlrev_b32 v62, v5, v62
    v_lshlrev_b32 v63, v5, v63
    v_pk_ashrrev_i16 v60, s57, v60
    v_pk_ashrrev_i16 v61, s57, v61
    v_pk_ashrrev_i16 v62, s57, v62
    v_pk_ashrrev_i16 v63, s57, v63
    v_and_b32 v60, v60, v56
    v_and_b32 v61, v61, v57
    v_and_b32 v62, v62, v58
    v_and_b32 v63, v63, v59
    v_cvt_pk_bf16_f32 v64, v64, v68
    v_cvt_pk_bf16_f32 v65, v65, v69
    v_cvt_pk_bf16_f32 v66, v66, v70
    v_cvt_pk_bf16_f32 v67, v67, v71
    s_nop 1
    v_mfma_f32_16x16x32_bf16 v[116:119], v[64:67], v[60:63], v[116:119]
    ds_read_b128 v[56:59], v3 offset:9856
    ds_read_b128 v[60:63], v3 offset:10048
    ds_write_b64 v4, v[8:9] offset:8624
    s_waitcnt lgkmcnt(3)
    buffer_load_dwordx4 v[36:39], v[12:13], s[8:11], 0 idxen offen
    ds_read_b32 v10, v2 offset:10192
    s_waitcnt vmcnt(1)
    v_mfma_f32_16x16x32_bf16 v[64:67], v[32:35], v[24:27], 0
    v_mfma_f32_16x16x32_bf16 v[68:71], v[32:35], v[28:31], 0
    v_lshlrev_b32 v52, v5, v52
    v_lshlrev_b32 v53, v5, v53
    v_lshlrev_b32 v54, v5, v54
    v_lshlrev_b32 v55, v5, v55
    v_pk_ashrrev_i16 v52, s57, v52
    v_pk_ashrrev_i16 v53, s57, v53
    v_pk_ashrrev_i16 v54, s57, v54
    v_pk_ashrrev_i16 v55, s57, v55
    v_and_b32 v52, v52, v48
    v_and_b32 v53, v53, v49
    v_and_b32 v54, v54, v50
    v_and_b32 v55, v55, v51
    v_cvt_pk_bf16_f32 v64, v64, v68
    v_cvt_pk_bf16_f32 v65, v65, v69
    v_cvt_pk_bf16_f32 v66, v66, v70
    v_cvt_pk_bf16_f32 v67, v67, v71
    s_nop 1
    v_mfma_f32_16x16x32_bf16 v[120:123], v[64:67], v[52:55], v[120:123]
    ds_read_b128 v[48:51], v3 offset:10576
    ds_read_b128 v[52:55], v3 offset:10768
    s_waitcnt lgkmcnt(2)
    buffer_load_dwordx4 v[32:35], v[10:11], s[8:11], 0 idxen offen
    ds_read_b32 v12, v2 offset:10320
    s_waitcnt vmcnt(1)
    v_mfma_f32_16x16x32_bf16 v[64:67], v[36:39], v[24:27], 0
    v_mfma_f32_16x16x32_bf16 v[68:71], v[36:39], v[28:31], 0
    v_lshlrev_b32 v60, v5, v60
    v_lshlrev_b32 v61, v5, v61
    v_lshlrev_b32 v62, v5, v62
    v_lshlrev_b32 v63, v5, v63
    v_pk_ashrrev_i16 v60, s57, v60
    v_pk_ashrrev_i16 v61, s57, v61
    v_pk_ashrrev_i16 v62, s57, v62
    v_pk_ashrrev_i16 v63, s57, v63
    v_and_b32 v60, v60, v56
    v_and_b32 v61, v61, v57
    v_and_b32 v62, v62, v58
    v_and_b32 v63, v63, v59
    v_cvt_pk_bf16_f32 v64, v64, v68
    v_cvt_pk_bf16_f32 v65, v65, v69
    v_cvt_pk_bf16_f32 v66, v66, v70
    v_cvt_pk_bf16_f32 v67, v67, v71
    s_nop 1
    v_mfma_f32_16x16x32_bf16 v[120:123], v[64:67], v[60:63], v[120:123]
    ds_read_b128 v[56:59], v3 offset:10640
    ds_read_b128 v[60:63], v3 offset:10832
    ds_write_b64 v4, v[8:9] offset:9408
    s_waitcnt lgkmcnt(3)
    buffer_load_dwordx4 v[36:39], v[12:13], s[8:11], 0 idxen offen
    s_waitcnt vmcnt(1)
    v_mfma_f32_16x16x32_bf16 v[64:67], v[32:35], v[24:27], 0
    v_mfma_f32_16x16x32_bf16 v[68:71], v[32:35], v[28:31], 0
    v_lshlrev_b32 v52, v5, v52
    v_lshlrev_b32 v53, v5, v53
    v_lshlrev_b32 v54, v5, v54
    v_lshlrev_b32 v55, v5, v55
    v_pk_ashrrev_i16 v52, s57, v52
    v_pk_ashrrev_i16 v53, s57, v53
    v_pk_ashrrev_i16 v54, s57, v54
    v_pk_ashrrev_i16 v55, s57, v55
    v_and_b32 v52, v52, v48
    v_and_b32 v53, v53, v49
    v_and_b32 v54, v54, v50
    v_and_b32 v55, v55, v51
    v_cvt_pk_bf16_f32 v64, v64, v68
    v_cvt_pk_bf16_f32 v65, v65, v69
    v_cvt_pk_bf16_f32 v66, v66, v70
    v_cvt_pk_bf16_f32 v67, v67, v71
    s_nop 1
    v_mfma_f32_16x16x32_bf16 v[124:127], v[64:67], v[52:55], v[124:127]
    s_waitcnt lgkmcnt(0)
    s_waitcnt vmcnt(0)
    v_mfma_f32_16x16x32_bf16 v[64:67], v[36:39], v[24:27], 0
    v_mfma_f32_16x16x32_bf16 v[68:71], v[36:39], v[28:31], 0
    v_lshlrev_b32 v60, v5, v60
    v_lshlrev_b32 v61, v5, v61
    v_lshlrev_b32 v62, v5, v62
    v_lshlrev_b32 v63, v5, v63
    v_pk_ashrrev_i16 v60, s57, v60
    v_pk_ashrrev_i16 v61, s57, v61
    v_pk_ashrrev_i16 v62, s57, v62
    v_pk_ashrrev_i16 v63, s57, v63
    v_and_b32 v60, v60, v56
    v_and_b32 v61, v61, v57
    v_and_b32 v62, v62, v58
    v_and_b32 v63, v63, v59
    v_cvt_pk_bf16_f32 v64, v64, v68
    v_cvt_pk_bf16_f32 v65, v65, v69
    v_cvt_pk_bf16_f32 v66, v66, v70
    v_cvt_pk_bf16_f32 v67, v67, v71
    s_nop 1
    v_mfma_f32_16x16x32_bf16 v[124:127], v[64:67], v[60:63], v[124:127]
    ds_write_b64 v4, v[8:9] offset:10192
K2_cdone:
    s_mul_i32 s48, s3, 10976
    s_add_u32 s48, s48, 1088
    v_mbcnt_lo_u32_b32 v8, -1, 0
    v_mbcnt_hi_u32_b32 v8, -1, v8
    v_lshlrev_b32 v8, 4, v8
    v_add_u32 v8, s48, v8
    v_add_u32 v9, 76832, v8
    s_nop 4
    ds_write_b128 v8, v[72:75] offset:0
    ds_write_b128 v8, v[76:79] offset:1024
    ds_write_b128 v8, v[80:83] offset:2048
    ds_write_b128 v8, v[84:87] offset:3072
    ds_write_b128 v8, v[88:91] offset:4096
    ds_write_b128 v8, v[92:95] offset:5120
    ds_write_b128 v8, v[96:99] offset:6144
    ds_write_b128 v8, v[100:103] offset:7168
    ds_write_b128 v8, v[104:107] offset:8192
    ds_write_b128 v8, v[108:111] offset:9216
    ds_write_b128 v9, v[112:115] offset:0
    ds_write_b128 v9, v[116:119] offset:1024
    ds_write_b128 v9, v[120:123] offset:2048
    ds_write_b128 v9, v[124:127] offset:3072
    v_mov_b32 v8, 1024
    v_mov_b32 v9, s62
    s_cmp_eq_u32 s62, 0
    s_cbranch_scc1 K2_noovf
    ds_write_b32 v8, v9
K2_noovf:
    s_waitcnt lgkmcnt(0)
    s_barrier
    s_endpgm
K2_producer:
    s_setprio 0
    s_sub_u32 s3, s3, 7
    s_add_u32 s16, s6, 41943040
    s_addc_u32 s17, s7, 0
    s_mov_b32 s18, 2097152
    s_mov_b32 s19, 0x20000
    s_and_b32 s64, s2, 7
    s_lshl_b32 s64, s64, 5
    s_lshr_b32 s65, s2, 3
    s_add_u32 s65, s65, s64
    s_lshl_b32 s65, s65, 5
    v_lshrrev_b32 v9, 1, v1
    v_lshlrev_b32 v9, 4, v9
    v_and_b32 v10, 1, v1
    v_add_u32 v9, v9, v10
    s_lshl_b32 s64, s3, 1
    v_add_u32 v10, s64, v9
    v_lshlrev_b32 v10, 13, v10
    v_add_u32 v10, s65, v10
    buffer_load_dwordx4 v[16:19], v10, s[16:19], 0 offen
    buffer_load_dwordx4 v[20:23], v10, s[16:19], 0 offen offset:16
    s_mov_b32 s64, 150016
    v_mul_lo_u32 v8, v9, s64
    s_mul_i32 s64, s3, 300032
    s_add_u32 s12, s6, s64
    s_addc_u32 s13, s7, 0
    s_sub_u32 s14, 38404096, s64
    s_mov_b32 s15, 0x20000
    v_and_b32 v9, 31, v1
    v_lshrrev_b32 v10, 1, v9
    v_mul_u32_u24 v10, 12, v10
    v_and_b32 v9, 1, v9
    v_lshl_add_u32 v2, v9, 3, v10
    v_lshl_add_u32 v3, v9, 1, v10
    v_add_u32 v3, 4, v3
    v_lshrrev_b32 v91, 4, v1
    v_lshlrev_b32 v91, 2, v91
    v_and_b32 v9, 15, v1
    v_mul_u32_u24 v92, 12, v9
    v_lshlrev_b32 v9, 1, v9
    v_sub_u32 v93, 31, v9
    v_sub_u32 v94, 30, v9
    s_mov_b32 s57, 0x0c040100
    v_mov_b32 v4, 784
    v_mov_b32 v7, 1
    v_mov_b32 v13, -1
    v_mov_b32 v90, 95
    v_mov_b32 v5, 1088
    v_mov_b32 v6, 0
    s_movk_i32 s60, 0x1fc
    s_mov_b32 s61, 76832
    s_movk_i32 s62, 512
    s_waitcnt vmcnt(0)
    v_and_b32 v9, 1, v16
    v_lshrrev_b32 v10, 16, v16
    v_add_u32 v10, v10, v9
    v_and_b32 v12, 0xfffe, v16
    v_cmp_lt_u32 s[58:59], 32, v10
    v_min_u32 v10, 32, v10
    v_sub_u32 v10, v10, v9
    v_mad_u32_u24 v12, v12, 6, v8
    v_cmp_eq_u32 vcc, 32, v10
    v_bfm_b32 v11, v10, v9
    s_mov_b32 s59, 0
    s_nop 0
    v_cndmask_b32 v11, v11, v13, vcc
    s_nop 0
    ds_bpermute_b32 v24, v91, v12 offset:0
    ds_bpermute_b32 v25, v91, v11 offset:0
    ds_bpermute_b32 v26, v91, v12 offset:16
    ds_bpermute_b32 v27, v91, v11 offset:16
    ds_bpermute_b32 v28, v91, v12 offset:32
    ds_bpermute_b32 v29, v91, v11 offset:32
    ds_bpermute_b32 v30, v91, v12 offset:48
    ds_bpermute_b32 v31, v91, v11 offset:48
    s_waitcnt lgkmcnt(0)
    v_lshlrev_b32 v9, v93, v25
    v_lshlrev_b32 v10, v94, v25
    v_add_u32 v24, v24, v92
    v_cmp_gt_i32 s[24:25], 0, v9
    v_cmp_gt_i32 s[26:27], 0, v10
    v_lshlrev_b32 v9, v93, v27
    v_lshlrev_b32 v10, v94, v27
    v_add_u32 v26, v26, v92
    v_cmp_gt_i32 s[28:29], 0, v9
    v_cmp_gt_i32 s[30:31], 0, v10
    v_lshlrev_b32 v9, v93, v29
    v_lshlrev_b32 v10, v94, v29
    v_add_u32 v28, v28, v92
    v_cmp_gt_i32 s[32:33], 0, v9
    v_cmp_gt_i32 s[34:35], 0, v10
    v_lshlrev_b32 v9, v93, v31
    v_lshlrev_b32 v10, v94, v31
    v_add_u32 v30, v30, v92
    v_cmp_gt_i32 s[36:37], 0, v9
    v_cmp_gt_i32 s[38:39], 0, v10
    s_or_b64 exec, s[24:25], s[26:27]
    buffer_load_dwordx3 v[40:42], v24, s[12:15], 0 offen
    s_or_b64 exec, s[28:29], s[30:31]
    buffer_load_dwordx3 v[44:46], v26, s[12:15], 0 offen
    s_or_b64 exec, s[32:33], s[34:35]
    buffer_load_dwordx3 v[48:50], v28, s[12:15], 0 offen
    s_or_b64 exec, s[36:37], s[38:39]
    buffer_load_dwordx3 v[52:54], v30, s[12:15], 0 offen
    s_mov_b64 exec, -1
    ds_bpermute_b32 v32, v91, v12 offset:64
    ds_bpermute_b32 v33, v91, v11 offset:64
    ds_bpermute_b32 v34, v91, v12 offset:80
    ds_bpermute_b32 v35, v91, v11 offset:80
    ds_bpermute_b32 v36, v91, v12 offset:96
    ds_bpermute_b32 v37, v91, v11 offset:96
    ds_bpermute_b32 v38, v91, v12 offset:112
    ds_bpermute_b32 v39, v91, v11 offset:112
    s_waitcnt lgkmcnt(0)
    v_lshlrev_b32 v9, v93, v33
    v_lshlrev_b32 v10, v94, v33
    v_add_u32 v32, v32, v92
    v_cmp_gt_i32 s[40:41], 0, v9
    v_cmp_gt_i32 s[42:43], 0, v10
    v_lshlrev_b32 v9, v93, v35
    v_lshlrev_b32 v10, v94, v35
    v_add_u32 v34, v34, v92
    v_cmp_gt_i32 s[44:45], 0, v9
    v_cmp_gt_i32 s[46:47], 0, v10
    v_lshlrev_b32 v9, v93, v37
    v_lshlrev_b32 v10, v94, v37
    v_add_u32 v36, v36, v92
    v_cmp_gt_i32 s[48:49], 0, v9
    v_cmp_gt_i32 s[50:51], 0, v10
    v_lshlrev_b32 v9, v93, v39
    v_lshlrev_b32 v10, v94, v39
    v_add_u32 v38, v38, v92
    v_cmp_gt_i32 s[52:53], 0, v9
    v_cmp_gt_i32 s[54:55], 0, v10
    s_or_b64 exec, s[40:41], s[42:43]
    buffer_load_dwordx3 v[56:58], v32, s[12:15], 0 offen
    s_or_b64 exec, s[44:45], s[46:47]
    buffer_load_dwordx3 v[60:62], v34, s[12:15], 0 offen
    s_or_b64 exec, s[48:49], s[50:51]
    buffer_load_dwordx3 v[64:66], v36, s[12:15], 0 offen
    s_or_b64 exec, s[52:53], s[54:55]
    buffer_load_dwordx3 v[68:70], v38, s[12:15], 0 offen
    s_mov_b64 exec, -1
    s_barrier
    s_waitcnt vmcnt(0) lgkmcnt(0)
    s_mov_b64 exec, s[24:25]
    v_lshrrev_b32 v9, 2, v41
    v_and_or_b32 v9, v9, s60, v6
    ds_add_rtn_u32 v24, v9, v7
    s_mov_b64 exec, s[26:27]
    v_lshrrev_b32 v9, 18, v41
    v_and_or_b32 v9, v9, s60, v6
    ds_add_rtn_u32 v25, v9, v7
    s_mov_b64 exec, s[28:29]
    v_lshrrev_b32 v9, 2, v45
    v_and_or_b32 v9, v9, s60, v6
    ds_add_rtn_u32 v26, v9, v7
    s_mov_b64 exec, s[30:31]
    v_lshrrev_b32 v9, 18, v45
    v_and_or_b32 v9, v9, s60, v6
    ds_add_rtn_u32 v27, v9, v7
    s_mov_b64 exec, s[32:33]
    v_lshrrev_b32 v9, 2, v49
    v_and_or_b32 v9, v9, s60, v6
    ds_add_rtn_u32 v28, v9, v7
    s_mov_b64 exec, s[34:35]
    v_lshrrev_b32 v9, 18, v49
    v_and_or_b32 v9, v9, s60, v6
    ds_add_rtn_u32 v29, v9, v7
    s_mov_b64 exec, s[36:37]
    v_lshrrev_b32 v9, 2, v53
    v_and_or_b32 v9, v9, s60, v6
    ds_add_rtn_u32 v30, v9, v7
    s_mov_b64 exec, s[38:39]
    v_lshrrev_b32 v9, 18, v53
    v_and_or_b32 v9, v9, s60, v6
    ds_add_rtn_u32 v31, v9, v7
    s_mov_b64 exec, s[24:25]
    v_bfe_u32 v9, v41, 4, 7
    v_lshlrev_b16 v10, v41, v7
    v_bfe_u32 v95, v41, 15, 1
    v_mad_u32_u24 v9, v9, v4, v5
    v_perm_b32 v95, v95, v40, s57
    s_waitcnt lgkmcnt(7)
    v_min_u32 v24, v90, v24
    v_lshl_add_u32 v96, v24, 2, v9
    v_lshl_add_u32 v9, v24, 1, v9
    ds_write_b32 v96, v95
    ds_write_b16_d16_hi v9, v40 offset:384
    ds_write_b16 v9, v10 offset:576
    s_mov_b64 exec, s[26:27]
    v_lshrrev_b32 v10, 16, v41
    v_bfe_u32 v9, v41, 20, 7
    v_lshrrev_b32 v95, 31, v41
    v_lshlrev_b16 v10, v10, v7
    v_mad_u32_u24 v9, v9, v4, v5
    v_perm_b32 v95, v95, v42, s57
    s_waitcnt lgkmcnt(9)
    v_min_u32 v25, v90, v25
    v_lshl_add_u32 v96, v25, 2, v9
    v_lshl_add_u32 v9, v25, 1, v9
    ds_write_b32 v96, v95
    ds_write_b16_d16_hi v9, v42 offset:384
    ds_write_b16 v9, v10 offset:576
    s_mov_b64 exec, s[28:29]
    v_bfe_u32 v9, v45, 4, 7
    v_lshlrev_b16 v10, v45, v7
    v_bfe_u32 v95, v45, 15, 1
    v_mad_u32_u24 v9, v9, v4, v5
    v_perm_b32 v95, v95, v44, s57
    s_waitcnt lgkmcnt(11)
    v_min_u32 v26, v90, v26
    v_lshl_add_u32 v96, v26, 2, v9
    v_lshl_add_u32 v9, v26, 1, v9
    ds_write_b32 v96, v95
    ds_write_b16_d16_hi v9, v44 offset:384
    ds_write_b16 v9, v10 offset:576
    s_mov_b64 exec, s[30:31]
    v_lshrrev_b32 v10, 16, v45
    v_bfe_u32 v9, v45, 20, 7
    v_lshrrev_b32 v95, 31, v45
    v_lshlrev_b16 v10, v10, v7
    v_mad_u32_u24 v9, v9, v4, v5
    v_perm_b32 v95, v95, v46, s57
    s_waitcnt lgkmcnt(13)
    v_min_u32 v27, v90, v27
    v_lshl_add_u32 v96, v27, 2, v9
    v_lshl_add_u32 v9, v27, 1, v9
    ds_write_b32 v96, v95
    ds_write_b16_d16_hi v9, v46 offset:384
    ds_write_b16 v9, v10 offset:576
    s_mov_b64 exec, s[32:33]
    v_bfe_u32 v9, v49, 4, 7
    v_lshlrev_b16 v10, v49, v7
    v_bfe_u32 v95, v49, 15, 1
    v_mad_u32_u24 v9, v9, v4, v5
    v_perm_b32 v95, v95, v48, s57
    s_waitcnt lgkmcnt(15)
    v_min_u32 v28, v90, v28
    v_lshl_add_u32 v96, v28, 2, v9
    v_lshl_add_u32 v9, v28, 1, v9
    ds_write_b32 v96, v95
    ds_write_b16_d16_hi v9, v48 offset:384
    ds_write_b16 v9, v10 offset:576
    s_mov_b64 exec, s[34:35]
    v_lshrrev_b32 v10, 16, v49
    v_bfe_u32 v9, v49, 20, 7
    v_lshrrev_b32 v95, 31, v49
    v_lshlrev_b16 v10, v10, v7
    v_mad_u32_u24 v9, v9, v4, v5
    v_perm_b32 v95, v95, v50, s57
    s_waitcnt lgkmcnt(15)
    v_min_u32 v29, v90, v29
    v_lshl_add_u32 v96, v29, 2, v9
    v_lshl_add_u32 v9, v29, 1, v9
    ds_write_b32 v96, v95
    ds_write_b16_d16_hi v9, v50 offset:384
    ds_write_b16 v9, v10 offset:576
    s_mov_b64 exec, s[36:37]
    v_bfe_u32 v9, v53, 4, 7
    v_lshlrev_b16 v10, v53, v7
    v_bfe_u32 v95, v53, 15, 1
    v_mad_u32_u24 v9, v9, v4, v5
    v_perm_b32 v95, v95, v52, s57
    s_waitcnt lgkmcnt(15)
    v_min_u32 v30, v90, v30
    v_lshl_add_u32 v96, v30, 2, v9
    v_lshl_add_u32 v9, v30, 1, v9
    ds_write_b32 v96, v95
    ds_write_b16_d16_hi v9, v52 offset:384
    ds_write_b16 v9, v10 offset:576
    s_mov_b64 exec, s[38:39]
    v_lshrrev_b32 v10, 16, v53
    v_bfe_u32 v9, v53, 20, 7
    v_lshrrev_b32 v95, 31, v53
    v_lshlrev_b16 v10, v10, v7
    v_mad_u32_u24 v9, v9, v4, v5
    v_perm_b32 v95, v95, v54, s57
    s_waitcnt lgkmcnt(15)
    v_min_u32 v31, v90, v31
    v_lshl_add_u32 v96, v31, 2, v9
    v_lshl_add_u32 v9, v31, 1, v9
    ds_write_b32 v96, v95
    ds_write_b16_d16_hi v9, v54 offset:384
    ds_write_b16 v9, v10 offset:576
    s_waitcnt lgkmcnt(0)
    s_mov_b64 exec, s[40:41]
    v_lshrrev_b32 v9, 2, v57
    v_and_or_b32 v9, v9, s60, v6
    ds_add_rtn_u32 v32, v9, v7
    s_mov_b64 exec, s[42:43]
    v_lshrrev_b32 v9, 18, v57
    v_and_or_b32 v9, v9, s60, v6
    ds_add_rtn_u32 v33, v9, v7
    s_mov_b64 exec, s[44:45]
    v_lshrrev_b32 v9, 2, v61
    v_and_or_b32 v9, v9, s60, v6
    ds_add_rtn_u32 v34, v9, v7
    s_mov_b64 exec, s[46:47]
    v_lshrrev_b32 v9, 18, v61
    v_and_or_b32 v9, v9, s60, v6
    ds_add_rtn_u32 v35, v9, v7
    s_mov_b64 exec, s[48:49]
    v_lshrrev_b32 v9, 2, v65
    v_and_or_b32 v9, v9, s60, v6
    ds_add_rtn_u32 v36, v9, v7
    s_mov_b64 exec, s[50:51]
    v_lshrrev_b32 v9, 18, v65
    v_and_or_b32 v9, v9, s60, v6
    ds_add_rtn_u32 v37, v9, v7
    s_mov_b64 exec, s[52:53]
    v_lshrrev_b32 v9, 2, v69
    v_and_or_b32 v9, v9, s60, v6
    ds_add_rtn_u32 v38, v9, v7
    s_mov_b64 exec, s[54:55]
    v_lshrrev_b32 v9, 18, v69
    v_and_or_b32 v9, v9, s60, v6
    ds_add_rtn_u32 v39, v9, v7
    s_mov_b64 exec, s[40:41]
    v_bfe_u32 v9, v57, 4, 7
    v_lshlrev_b16 v10, v57, v7
    v_bfe_u32 v95, v57, 15, 1
    v_mad_u32_u24 v9, v9, v4, v5
    v_perm_b32 v95, v95, v56, s57
    s_waitcnt lgkmcnt(7)
    v_min_u32 v32, v90, v32
    v_lshl_add_u32 v96, v32, 2, v9
    v_lshl_add_u32 v9, v32, 1, v9
    ds_write_b32 v96, v95
    ds_write_b16_d16_hi v9, v56 offset:384
    ds_write_b16 v9, v10 offset:576
    s_mov_b64 exec, s[42:43]
    v_lshrrev_b32 v10, 16, v57
    v_bfe_u32 v9, v57, 20, 7
    v_lshrrev_b32 v95, 31, v57
    v_lshlrev_b16 v10, v10, v7
    v_mad_u32_u24 v9, v9, v4, v5
    v_perm_b32 v95, v95, v58, s57
    s_waitcnt lgkmcnt(9)
    v_min_u32 v33, v90, v33
    v_lshl_add_u32 v96, v33, 2, v9
    v_lshl_add_u32 v9, v33, 1, v9
    ds_write_b32 v96, v95
    ds_write_b16_d16_hi v9, v58 offset:384
    ds_write_b16 v9, v10 offset:576
    s_mov_b64 exec, s[44:45]
    v_bfe_u32 v9, v61, 4, 7
    v_lshlrev_b16 v10, v61, v7
    v_bfe_u32 v95, v61, 15, 1
    v_mad_u32_u24 v9, v9, v4, v5
    v_perm_b32 v95, v95, v60, s57
    s_waitcnt lgkmcnt(11)
    v_min_u32 v34, v90, v34
    v_lshl_add_u32 v96, v34, 2, v9
    v_lshl_add_u32 v9, v34, 1, v9
    ds_write_b32 v96, v95
    ds_write_b16_d16_hi v9, v60 offset:384
    ds_write_b16 v9, v10 offset:576
    s_mov_b64 exec, s[46:47]
    v_lshrrev_b32 v10, 16, v61
    v_bfe_u32 v9, v61, 20, 7
    v_lshrrev_b32 v95, 31, v61
    v_lshlrev_b16 v10, v10, v7
    v_mad_u32_u24 v9, v9, v4, v5
    v_perm_b32 v95, v95, v62, s57
    s_waitcnt lgkmcnt(13)
    v_min_u32 v35, v90, v35
    v_lshl_add_u32 v96, v35, 2, v9
    v_lshl_add_u32 v9, v35, 1, v9
    ds_write_b32 v96, v95
    ds_write_b16_d16_hi v9, v62 offset:384
    ds_write_b16 v9, v10 offset:576
    s_mov_b64 exec, s[48:49]
    v_bfe_u32 v9, v65, 4, 7
    v_lshlrev_b16 v10, v65, v7
    v_bfe_u32 v95, v65, 15, 1
    v_mad_u32_u24 v9, v9, v4, v5
    v_perm_b32 v95, v95, v64, s57
    s_waitcnt lgkmcnt(15)
    v_min_u32 v36, v90, v36
    v_lshl_add_u32 v96, v36, 2, v9
    v_lshl_add_u32 v9, v36, 1, v9
    ds_write_b32 v96, v95
    ds_write_b16_d16_hi v9, v64 offset:384
    ds_write_b16 v9, v10 offset:576
    s_mov_b64 exec, s[50:51]
    v_lshrrev_b32 v10, 16, v65
    v_bfe_u32 v9, v65, 20, 7
    v_lshrrev_b32 v95, 31, v65
    v_lshlrev_b16 v10, v10, v7
    v_mad_u32_u24 v9, v9, v4, v5
    v_perm_b32 v95, v95, v66, s57
    s_waitcnt lgkmcnt(15)
    v_min_u32 v37, v90, v37
    v_lshl_add_u32 v96, v37, 2, v9
    v_lshl_add_u32 v9, v37, 1, v9
    ds_write_b32 v96, v95
    ds_write_b16_d16_hi v9, v66 offset:384
    ds_write_b16 v9, v10 offset:576
    s_mov_b64 exec, s[52:53]
    v_bfe_u32 v9, v69, 4, 7
    v_lshlrev_b16 v10, v69, v7
    v_bfe_u32 v95, v69, 15, 1
    v_mad_u32_u24 v9, v9, v4, v5
    v_perm_b32 v95, v95, v68, s57
    s_waitcnt lgkmcnt(15)
    v_min_u32 v38, v90, v38
    v_lshl_add_u32 v96, v38, 2, v9
    v_lshl_add_u32 v9, v38, 1, v9
    ds_write_b32 v96, v95
    ds_write_b16_d16_hi v9, v68 offset:384
    ds_write_b16 v9, v10 offset:576
    s_mov_b64 exec, s[54:55]
    v_lshrrev_b32 v10, 16, v69
    v_bfe_u32 v9, v69, 20, 7
    v_lshrrev_b32 v95, 31, v69
    v_lshlrev_b16 v10, v10, v7
    v_mad_u32_u24 v9, v9, v4, v5
    v_perm_b32 v95, v95, v70, s57
    s_waitcnt lgkmcnt(15)
    v_min_u32 v39, v90, v39
    v_lshl_add_u32 v96, v39, 2, v9
    v_lshl_add_u32 v9, v39, 1, v9
    ds_write_b32 v96, v95
    ds_write_b16_d16_hi v9, v70 offset:384
    ds_write_b16 v9, v10 offset:576
    s_mov_b64 exec, -1
    s_cmp_eq_u32 s58, 0
    s_cbranch_scc1 K2_nolong_p
K2_long_p:
    s_ff1_i32_b32 s64, s58
    s_bitset0_b32 s58, s64
    v_readlane_b32 s65, v16, s64
    v_readlane_b32 s66, v8, s64
    s_nop 3
    s_and_b32 s67, s65, 0xffff
    s_lshr_b32 s68, s65, 16
    s_and_b32 s69, s67, 1
    s_sub_u32 s69, 32, s69
    s_add_u32 s67, s67, s69
    s_sub_u32 s68, s68, s69
K2_longloop_p:
    s_and_b32 s69, s67, 1
    s_sub_u32 s70, 32, s69
    s_min_u32 s70, s70, s68
    s_bfm_b64 s[72:73], s70, s69
    s_sub_u32 s71, s67, s69
    s_mul_i32 s71, s71, 6
    s_add_u32 s71, s71, s66
    s_mov_b32 exec_lo, s72
    s_mov_b32 exec_hi, 0
    buffer_load_dword v24, v2, s[12:15], s71 offen
    buffer_load_ushort v25, v3, s[12:15], s71 offen
    s_waitcnt vmcnt(0)
    v_lshrrev_b32 v9, 2, v25
    v_and_or_b32 v9, v9, s60, v6
    ds_add_rtn_u32 v26, v9, v7
    s_waitcnt lgkmcnt(0)
    v_min_u32 v26, v90, v26
    v_bfe_u32 v9, v25, 4, 7
    v_lshlrev_b16 v10, v25, v7
    v_lshrrev_b32 v95, 15, v25
    v_mad_u32_u24 v9, v9, v4, v5
    v_perm_b32 v95, v95, v24, s57
    v_lshl_add_u32 v96, v26, 2, v9
    v_lshl_add_u32 v9, v26, 1, v9
    ds_write_b32 v96, v95
    ds_write_b16_d16_hi v9, v24 offset:384
    ds_write_b16 v9, v10 offset:576
    s_mov_b64 exec, -1
    s_add_u32 s67, s67, s70
    s_sub_u32 s68, s68, s70
    s_cmp_lg_u32 s68, 0
    s_cbranch_scc1 K2_longloop_p
    s_cmp_lg_u32 s58, 0
    s_cbranch_scc1 K2_long_p
K2_nolong_p:
    v_mov_b32 v16, v17
    v_mov_b32 v17, v18
    v_mov_b32 v18, v19
    v_mov_b32 v19, v20
    v_mov_b32 v20, v21
    v_mov_b32 v21, v22
    v_mov_b32 v22, v23
    s_waitcnt lgkmcnt(0)
    s_barrier
    v_and_b32 v9, 1, v16
    v_lshrrev_b32 v10, 16, v16
    v_add_u32 v10, v10, v9
    v_and_b32 v12, 0xfffe, v16
    v_cmp_lt_u32 s[58:59], 32, v10
    v_min_u32 v10, 32, v10
    v_sub_u32 v10, v10, v9
    v_mad_u32_u24 v12, v12, 6, v8
    v_cmp_eq_u32 vcc, 32, v10
    v_bfm_b32 v11, v10, v9
    s_mov_b32 s59, 0
    s_nop 0
    v_cndmask_b32 v11, v11, v13, vcc
    s_nop 0
    ds_bpermute_b32 v24, v91, v12 offset:0
    ds_bpermute_b32 v25, v91, v11 offset:0
    ds_bpermute_b32 v26, v91, v12 offset:16
    ds_bpermute_b32 v27, v91, v11 offset:16
    ds_bpermute_b32 v28, v91, v12 offset:32
    ds_bpermute_b32 v29, v91, v11 offset:32
    ds_bpermute_b32 v30, v91, v12 offset:48
    ds_bpermute_b32 v31, v91, v11 offset:48
    s_waitcnt lgkmcnt(0)
    v_lshlrev_b32 v9, v93, v25
    v_lshlrev_b32 v10, v94, v25
    v_add_u32 v24, v24, v92
    v_cmp_gt_i32 s[24:25], 0, v9
    v_cmp_gt_i32 s[26:27], 0, v10
    v_lshlrev_b32 v9, v93, v27
    v_lshlrev_b32 v10, v94, v27
    v_add_u32 v26, v26, v92
    v_cmp_gt_i32 s[28:29], 0, v9
    v_cmp_gt_i32 s[30:31], 0, v10
    v_lshlrev_b32 v9, v93, v29
    v_lshlrev_b32 v10, v94, v29
    v_add_u32 v28, v28, v92
    v_cmp_gt_i32 s[32:33], 0, v9
    v_cmp_gt_i32 s[34:35], 0, v10
    v_lshlrev_b32 v9, v93, v31
    v_lshlrev_b32 v10, v94, v31
    v_add_u32 v30, v30, v92
    v_cmp_gt_i32 s[36:37], 0, v9
    v_cmp_gt_i32 s[38:39], 0, v10
    s_or_b64 exec, s[24:25], s[26:27]
    buffer_load_dwordx3 v[40:42], v24, s[12:15], 0 offen
    s_or_b64 exec, s[28:29], s[30:31]
    buffer_load_dwordx3 v[44:46], v26, s[12:15], 0 offen
    s_or_b64 exec, s[32:33], s[34:35]
    buffer_load_dwordx3 v[48:50], v28, s[12:15], 0 offen
    s_or_b64 exec, s[36:37], s[38:39]
    buffer_load_dwordx3 v[52:54], v30, s[12:15], 0 offen
    s_mov_b64 exec, -1
    ds_bpermute_b32 v32, v91, v12 offset:64
    ds_bpermute_b32 v33, v91, v11 offset:64
    ds_bpermute_b32 v34, v91, v12 offset:80
    ds_bpermute_b32 v35, v91, v11 offset:80
    ds_bpermute_b32 v36, v91, v12 offset:96
    ds_bpermute_b32 v37, v91, v11 offset:96
    ds_bpermute_b32 v38, v91, v12 offset:112
    ds_bpermute_b32 v39, v91, v11 offset:112
    s_waitcnt lgkmcnt(0)
    v_lshlrev_b32 v9, v93, v33
    v_lshlrev_b32 v10, v94, v33
    v_add_u32 v32, v32, v92
    v_cmp_gt_i32 s[40:41], 0, v9
    v_cmp_gt_i32 s[42:43], 0, v10
    v_lshlrev_b32 v9, v93, v35
    v_lshlrev_b32 v10, v94, v35
    v_add_u32 v34, v34, v92
    v_cmp_gt_i32 s[44:45], 0, v9
    v_cmp_gt_i32 s[46:47], 0, v10
    v_lshlrev_b32 v9, v93, v37
    v_lshlrev_b32 v10, v94, v37
    v_add_u32 v36, v36, v92
    v_cmp_gt_i32 s[48:49], 0, v9
    v_cmp_gt_i32 s[50:51], 0, v10
    v_lshlrev_b32 v9, v93, v39
    v_lshlrev_b32 v10, v94, v39
    v_add_u32 v38, v38, v92
    v_cmp_gt_i32 s[52:53], 0, v9
    v_cmp_gt_i32 s[54:55], 0, v10
    s_or_b64 exec, s[40:41], s[42:43]
    buffer_load_dwordx3 v[56:58], v32, s[12:15], 0 offen
    s_or_b64 exec, s[44:45], s[46:47]
    buffer_load_dwordx3 v[60:62], v34, s[12:15], 0 offen
    s_or_b64 exec, s[48:49], s[50:51]
    buffer_load_dwordx3 v[64:66], v36, s[12:15], 0 offen
    s_or_b64 exec, s[52:53], s[54:55]
    buffer_load_dwordx3 v[68:70], v38, s[12:15], 0 offen
    s_mov_b64 exec, -1
    v_add_u32 v5, s61, v5
    v_add_u32 v6, s62, v6
    s_sub_u32 s61, 0, s61
    s_sub_u32 s62, 0, s62
    s_mov_b32 s63, 0
K2_ploop:
    s_mul_i32 s66, s63, 7
    v_mov_b32 v9, 0
K2_ppoll:
    ds_read_b32 v10, v9 offset:1032
    s_waitcnt lgkmcnt(0)
    v_readfirstlane_b32 s65, v10
    s_cmp_ge_u32 s65, s66
    s_cbranch_scc1 K2_pfree
    s_sleep 2
    s_branch K2_ppoll
K2_pfree:
    s_waitcnt vmcnt(0) lgkmcnt(0)
    s_mov_b64 exec, s[24:25]
    v_lshrrev_b32 v9, 2, v41
    v_and_or_b32 v9, v9, s60, v6
    ds_add_rtn_u32 v24, v9, v7
    s_mov_b64 exec, s[26:27]
    v_lshrrev_b32 v9, 18, v41
    v_and_or_b32 v9, v9, s60, v6
    ds_add_rtn_u32 v25, v9, v7
    s_mov_b64 exec, s[28:29]
    v_lshrrev_b32 v9, 2, v45
    v_and_or_b32 v9, v9, s60, v6
    ds_add_rtn_u32 v26, v9, v7
    s_mov_b64 exec, s[30:31]
    v_lshrrev_b32 v9, 18, v45
    v_and_or_b32 v9, v9, s60, v6
    ds_add_rtn_u32 v27, v9, v7
    s_mov_b64 exec, s[32:33]
    v_lshrrev_b32 v9, 2, v49
    v_and_or_b32 v9, v9, s60, v6
    ds_add_rtn_u32 v28, v9, v7
    s_mov_b64 exec, s[34:35]
    v_lshrrev_b32 v9, 18, v49
    v_and_or_b32 v9, v9, s60, v6
    ds_add_rtn_u32 v29, v9, v7
    s_mov_b64 exec, s[36:37]
    v_lshrrev_b32 v9, 2, v53
    v_and_or_b32 v9, v9, s60, v6
    ds_add_rtn_u32 v30, v9, v7
    s_mov_b64 exec, s[38:39]
    v_lshrrev_b32 v9, 18, v53
    v_and_or_b32 v9, v9, s60, v6
    ds_add_rtn_u32 v31, v9, v7
    s_mov_b64 exec, s[24:25]
    v_bfe_u32 v9, v41, 4, 7
    v_lshlrev_b16 v10, v41, v7
    v_bfe_u32 v95, v41, 15, 1
    v_mad_u32_u24 v9, v9, v4, v5
    v_perm_b32 v95, v95, v40, s57
    s_waitcnt lgkmcnt(7)
    v_min_u32 v24, v90, v24
    v_lshl_add_u32 v96, v24, 2, v9
    v_lshl_add_u32 v9, v24, 1, v9
    ds_write_b32 v96, v95
    ds_write_b16_d16_hi v9, v40 offset:384
    ds_write_b16 v9, v10 offset:576
    s_mov_b64 exec, s[26:27]
    v_lshrrev_b32 v10, 16, v41
    v_bfe_u32 v9, v41, 20, 7
    v_lshrrev_b32 v95, 31, v41
    v_lshlrev_b16 v10, v10, v7
    v_mad_u32_u24 v9, v9, v4, v5
    v_perm_b32 v95, v95, v42, s57
    s_waitcnt lgkmcnt(9)
    v_min_u32 v25, v90, v25
    v_lshl_add_u32 v96, v25, 2, v9
    v_lshl_add_u32 v9, v25, 1, v9
    ds_write_b32 v96, v95
    ds_write_b16_d16_hi v9, v42 offset:384
    ds_write_b16 v9, v10 offset:576
    s_mov_b64 exec, s[28:29]
    v_bfe_u32 v9, v45, 4, 7
    v_lshlrev_b16 v10, v45, v7
    v_bfe_u32 v95, v45, 15, 1
    v_mad_u32_u24 v9, v9, v4, v5
    v_perm_b32 v95, v95, v44, s57
    s_waitcnt lgkmcnt(11)
    v_min_u32 v26, v90, v26
    v_lshl_add_u32 v96, v26, 2, v9
    v_lshl_add_u32 v9, v26, 1, v9
    ds_write_b32 v96, v95
    ds_write_b16_d16_hi v9, v44 offset:384
    ds_write_b16 v9, v10 offset:576
    s_mov_b64 exec, s[30:31]
    v_lshrrev_b32 v10, 16, v45
    v_bfe_u32 v9, v45, 20, 7
    v_lshrrev_b32 v95, 31, v45
    v_lshlrev_b16 v10, v10, v7
    v_mad_u32_u24 v9, v9, v4, v5
    v_perm_b32 v95, v95, v46, s57
    s_waitcnt lgkmcnt(13)
    v_min_u32 v27, v90, v27
    v_lshl_add_u32 v96, v27, 2, v9
    v_lshl_add_u32 v9, v27, 1, v9
    ds_write_b32 v96, v95
    ds_write_b16_d16_hi v9, v46 offset:384
    ds_write_b16 v9, v10 offset:576
    s_mov_b64 exec, s[32:33]
    v_bfe_u32 v9, v49, 4, 7
    v_lshlrev_b16 v10, v49, v7
    v_bfe_u32 v95, v49, 15, 1
    v_mad_u32_u24 v9, v9, v4, v5
    v_perm_b32 v95, v95, v48, s57
    s_waitcnt lgkmcnt(15)
    v_min_u32 v28, v90, v28
    v_lshl_add_u32 v96, v28, 2, v9
    v_lshl_add_u32 v9, v28, 1, v9
    ds_write_b32 v96, v95
    ds_write_b16_d16_hi v9, v48 offset:384
    ds_write_b16 v9, v10 offset:576
    s_mov_b64 exec, s[34:35]
    v_lshrrev_b32 v10, 16, v49
    v_bfe_u32 v9, v49, 20, 7
    v_lshrrev_b32 v95, 31, v49
    v_lshlrev_b16 v10, v10, v7
    v_mad_u32_u24 v9, v9, v4, v5
    v_perm_b32 v95, v95, v50, s57
    s_waitcnt lgkmcnt(15)
    v_min_u32 v29, v90, v29
    v_lshl_add_u32 v96, v29, 2, v9
    v_lshl_add_u32 v9, v29, 1, v9
    ds_write_b32 v96, v95
    ds_write_b16_d16_hi v9, v50 offset:384
    ds_write_b16 v9, v10 offset:576
    s_mov_b64 exec, s[36:37]
    v_bfe_u32 v9, v53, 4, 7
    v_lshlrev_b16 v10, v53, v7
    v_bfe_u32 v95, v53, 15, 1
    v_mad_u32_u24 v9, v9, v4, v5
    v_perm_b32 v95, v95, v52, s57
    s_waitcnt lgkmcnt(15)
    v_min_u32 v30, v90, v30
    v_lshl_add_u32 v96, v30, 2, v9
    v_lshl_add_u32 v9, v30, 1, v9
    ds_write_b32 v96, v95
    ds_write_b16_d16_hi v9, v52 offset:384
    ds_write_b16 v9, v10 offset:576
    s_mov_b64 exec, s[38:39]
    v_lshrrev_b32 v10, 16, v53
    v_bfe_u32 v9, v53, 20, 7
    v_lshrrev_b32 v95, 31, v53
    v_lshlrev_b16 v10, v10, v7
    v_mad_u32_u24 v9, v9, v4, v5
    v_perm_b32 v95, v95, v54, s57
    s_waitcnt lgkmcnt(15)
    v_min_u32 v31, v90, v31
    v_lshl_add_u32 v96, v31, 2, v9
    v_lshl_add_u32 v9, v31, 1, v9
    ds_write_b32 v96, v95
    ds_write_b16_d16_hi v9, v54 offset:384
    ds_write_b16 v9, v10 offset:576
    s_waitcnt lgkmcnt(0)
    s_mov_b64 exec, s[40:41]
    v_lshrrev_b32 v9, 2, v57
    v_and_or_b32 v9, v9, s60, v6
    ds_add_rtn_u32 v32, v9, v7
    s_mov_b64 exec, s[42:43]
    v_lshrrev_b32 v9, 18, v57
    v_and_or_b32 v9, v9, s60, v6
    ds_add_rtn_u32 v33, v9, v7
    s_mov_b64 exec, s[44:45]
    v_lshrrev_b32 v9, 2, v61
    v_and_or_b32 v9, v9, s60, v6
    ds_add_rtn_u32 v34, v9, v7
    s_mov_b64 exec, s[46:47]
    v_lshrrev_b32 v9, 18, v61
    v_and_or_b32 v9, v9, s60, v6
    ds_add_rtn_u32 v35, v9, v7
    s_mov_b64 exec, s[48:49]
    v_lshrrev_b32 v9, 2, v65
    v_and_or_b32 v9, v9, s60, v6
    ds_add_rtn_u32 v36, v9, v7
    s_mov_b64 exec, s[50:51]
    v_lshrrev_b32 v9, 18, v65
    v_and_or_b32 v9, v9, s60, v6
    ds_add_rtn_u32 v37, v9, v7
    s_mov_b64 exec, s[52:53]
    v_lshrrev_b32 v9, 2, v69
    v_and_or_b32 v9, v9, s60, v6
    ds_add_rtn_u32 v38, v9, v7
    s_mov_b64 exec, s[54:55]
    v_lshrrev_b32 v9, 18, v69
    v_and_or_b32 v9, v9, s60, v6
    ds_add_rtn_u32 v39, v9, v7
    s_mov_b64 exec, s[40:41]
    v_bfe_u32 v9, v57, 4, 7
    v_lshlrev_b16 v10, v57, v7
    v_bfe_u32 v95, v57, 15, 1
    v_mad_u32_u24 v9, v9, v4, v5
    v_perm_b32 v95, v95, v56, s57
    s_waitcnt lgkmcnt(7)
    v_min_u32 v32, v90, v32
    v_lshl_add_u32 v96, v32, 2, v9
    v_lshl_add_u32 v9, v32, 1, v9
    ds_write_b32 v96, v95
    ds_write_b16_d16_hi v9, v56 offset:384
    ds_write_b16 v9, v10 offset:576
    s_mov_b64 exec, s[42:43]
    v_lshrrev_b32 v10, 16, v57
    v_bfe_u32 v9, v57, 20, 7
    v_lshrrev_b32 v95, 31, v57
    v_lshlrev_b16 v10, v10, v7
    v_mad_u32_u24 v9, v9, v4, v5
    v_perm_b32 v95, v95, v58, s57
    s_waitcnt lgkmcnt(9)
    v_min_u32 v33, v90, v33
    v_lshl_add_u32 v96, v33, 2, v9
    v_lshl_add_u32 v9, v33, 1, v9
    ds_write_b32 v96, v95
    ds_write_b16_d16_hi v9, v58 offset:384
    ds_write_b16 v9, v10 offset:576
    s_mov_b64 exec, s[44:45]
    v_bfe_u32 v9, v61, 4, 7
    v_lshlrev_b16 v10, v61, v7
    v_bfe_u32 v95, v61, 15, 1
    v_mad_u32_u24 v9, v9, v4, v5
    v_perm_b32 v95, v95, v60, s57
    s_waitcnt lgkmcnt(11)
    v_min_u32 v34, v90, v34
    v_lshl_add_u32 v96, v34, 2, v9
    v_lshl_add_u32 v9, v34, 1, v9
    ds_write_b32 v96, v95
    ds_write_b16_d16_hi v9, v60 offset:384
    ds_write_b16 v9, v10 offset:576
    s_mov_b64 exec, s[46:47]
    v_lshrrev_b32 v10, 16, v61
    v_bfe_u32 v9, v61, 20, 7
    v_lshrrev_b32 v95, 31, v61
    v_lshlrev_b16 v10, v10, v7
    v_mad_u32_u24 v9, v9, v4, v5
    v_perm_b32 v95, v95, v62, s57
    s_waitcnt lgkmcnt(13)
    v_min_u32 v35, v90, v35
    v_lshl_add_u32 v96, v35, 2, v9
    v_lshl_add_u32 v9, v35, 1, v9
    ds_write_b32 v96, v95
    ds_write_b16_d16_hi v9, v62 offset:384
    ds_write_b16 v9, v10 offset:576
    s_mov_b64 exec, s[48:49]
    v_bfe_u32 v9, v65, 4, 7
    v_lshlrev_b16 v10, v65, v7
    v_bfe_u32 v95, v65, 15, 1
    v_mad_u32_u24 v9, v9, v4, v5
    v_perm_b32 v95, v95, v64, s57
    s_waitcnt lgkmcnt(15)
    v_min_u32 v36, v90, v36
    v_lshl_add_u32 v96, v36, 2, v9
    v_lshl_add_u32 v9, v36, 1, v9
    ds_write_b32 v96, v95
    ds_write_b16_d16_hi v9, v64 offset:384
    ds_write_b16 v9, v10 offset:576
    s_mov_b64 exec, s[50:51]
    v_lshrrev_b32 v10, 16, v65
    v_bfe_u32 v9, v65, 20, 7
    v_lshrrev_b32 v95, 31, v65
    v_lshlrev_b16 v10, v10, v7
    v_mad_u32_u24 v9, v9, v4, v5
    v_perm_b32 v95, v95, v66, s57
    s_waitcnt lgkmcnt(15)
    v_min_u32 v37, v90, v37
    v_lshl_add_u32 v96, v37, 2, v9
    v_lshl_add_u32 v9, v37, 1, v9
    ds_write_b32 v96, v95
    ds_write_b16_d16_hi v9, v66 offset:384
    ds_write_b16 v9, v10 offset:576
    s_mov_b64 exec, s[52:53]
    v_bfe_u32 v9, v69, 4, 7
    v_lshlrev_b16 v10, v69, v7
    v_bfe_u32 v95, v69, 15, 1
    v_mad_u32_u24 v9, v9, v4, v5
    v_perm_b32 v95, v95, v68, s57
    s_waitcnt lgkmcnt(15)
    v_min_u32 v38, v90, v38
    v_lshl_add_u32 v96, v38, 2, v9
    v_lshl_add_u32 v9, v38, 1, v9
    ds_write_b32 v96, v95
    ds_write_b16_d16_hi v9, v68 offset:384
    ds_write_b16 v9, v10 offset:576
    s_mov_b64 exec, s[54:55]
    v_lshrrev_b32 v10, 16, v69
    v_bfe_u32 v9, v69, 20, 7
    v_lshrrev_b32 v95, 31, v69
    v_lshlrev_b16 v10, v10, v7
    v_mad_u32_u24 v9, v9, v4, v5
    v_perm_b32 v95, v95, v70, s57
    s_waitcnt lgkmcnt(15)
    v_min_u32 v39, v90, v39
    v_lshl_add_u32 v96, v39, 2, v9
    v_lshl_add_u32 v9, v39, 1, v9
    ds_write_b32 v96, v95
    ds_write_b16_d16_hi v9, v70 offset:384
    ds_write_b16 v9, v10 offset:576
    s_mov_b64 exec, -1
    s_cmp_eq_u32 s58, 0
    s_cbranch_scc1 K2_nolong_l
K2_long_l:
    s_ff1_i32_b32 s64, s58
    s_bitset0_b32 s58, s64
    v_readlane_b32 s65, v16, s64
    v_readlane_b32 s66, v8, s64
    s_nop 3
    s_and_b32 s67, s65, 0xffff
    s_lshr_b32 s68, s65, 16
    s_and_b32 s69, s67, 1
    s_sub_u32 s69, 32, s69
    s_add_u32 s67, s67, s69
    s_sub_u32 s68, s68, s69
K2_longloop_l:
    s_and_b32 s69, s67, 1
    s_sub_u32 s70, 32, s69
    s_min_u32 s70, s70, s68
    s_bfm_b64 s[72:73], s70, s69
    s_sub_u32 s71, s67, s69
    s_mul_i32 s71, s71, 6
    s_add_u32 s71, s71, s66
    s_mov_b32 exec_lo, s72
    s_mov_b32 exec_hi, 0
    buffer_load_dword v24, v2, s[12:15], s71 offen
    buffer_load_ushort v25, v3, s[12:15], s71 offen
    s_waitcnt vmcnt(0)
    v_lshrrev_b32 v9, 2, v25
    v_and_or_b32 v9, v9, s60, v6
    ds_add_rtn_u32 v26, v9, v7
    s_waitcnt lgkmcnt(0)
    v_min_u32 v26, v90, v26
    v_bfe_u32 v9, v25, 4, 7
    v_lshlrev_b16 v10, v25, v7
    v_lshrrev_b32 v95, 15, v25
    v_mad_u32_u24 v9, v9, v4, v5
    v_perm_b32 v95, v95, v24, s57
    v_lshl_add_u32 v96, v26, 2, v9
    v_lshl_add_u32 v9, v26, 1, v9
    ds_write_b32 v96, v95
    ds_write_b16_d16_hi v9, v24 offset:384
    ds_write_b16 v9, v10 offset:576
    s_mov_b64 exec, -1
    s_add_u32 s67, s67, s70
    s_sub_u32 s68, s68, s70
    s_cmp_lg_u32 s68, 0
    s_cbranch_scc1 K2_longloop_l
    s_cmp_lg_u32 s58, 0
    s_cbranch_scc1 K2_long_l
K2_nolong_l:
    s_waitcnt lgkmcnt(0)
    v_mov_b32 v9, 0
    s_mov_b64 exec, 1
    ds_add_u32 v9, v7 offset:1028
    s_mov_b64 exec, -1
    v_mov_b32 v16, v17
    v_mov_b32 v17, v18
    v_mov_b32 v18, v19
    v_mov_b32 v19, v20
    v_mov_b32 v20, v21
    v_mov_b32 v21, v22
    v_mov_b32 v22, v23
    s_cmp_ge_u32 s63, 3
    s_cbranch_scc1 K2_pnoload
    v_and_b32 v9, 1, v16
    v_lshrrev_b32 v10, 16, v16
    v_add_u32 v10, v10, v9
    v_and_b32 v12, 0xfffe, v16
    v_cmp_lt_u32 s[58:59], 32, v10
    v_min_u32 v10, 32, v10
    v_sub_u32 v10, v10, v9
    v_mad_u32_u24 v12, v12, 6, v8
    v_cmp_eq_u32 vcc, 32, v10
    v_bfm_b32 v11, v10, v9
    s_mov_b32 s59, 0
    s_nop 0
    v_cndmask_b32 v11, v11, v13, vcc
    s_nop 0
    ds_bpermute_b32 v24, v91, v12 offset:0
    ds_bpermute_b32 v25, v91, v11 offset:0
    ds_bpermute_b32 v26, v91, v12 offset:16
    ds_bpermute_b32 v27, v91, v11 offset:16
    ds_bpermute_b32 v28, v91, v12 offset:32
    ds_bpermute_b32 v29, v91, v11 offset:32
    ds_bpermute_b32 v30, v91, v12 offset:48
    ds_bpermute_b32 v31, v91, v11 offset:48
    s_waitcnt lgkmcnt(0)
    v_lshlrev_b32 v9, v93, v25
    v_lshlrev_b32 v10, v94, v25
    v_add_u32 v24, v24, v92
    v_cmp_gt_i32 s[24:25], 0, v9
    v_cmp_gt_i32 s[26:27], 0, v10
    v_lshlrev_b32 v9, v93, v27
    v_lshlrev_b32 v10, v94, v27
    v_add_u32 v26, v26, v92
    v_cmp_gt_i32 s[28:29], 0, v9
    v_cmp_gt_i32 s[30:31], 0, v10
    v_lshlrev_b32 v9, v93, v29
    v_lshlrev_b32 v10, v94, v29
    v_add_u32 v28, v28, v92
    v_cmp_gt_i32 s[32:33], 0, v9
    v_cmp_gt_i32 s[34:35], 0, v10
    v_lshlrev_b32 v9, v93, v31
    v_lshlrev_b32 v10, v94, v31
    v_add_u32 v30, v30, v92
    v_cmp_gt_i32 s[36:37], 0, v9
    v_cmp_gt_i32 s[38:39], 0, v10
    s_or_b64 exec, s[24:25], s[26:27]
    buffer_load_dwordx3 v[40:42], v24, s[12:15], 0 offen
    s_or_b64 exec, s[28:29], s[30:31]
    buffer_load_dwordx3 v[44:46], v26, s[12:15], 0 offen
    s_or_b64 exec, s[32:33], s[34:35]
    buffer_load_dwordx3 v[48:50], v28, s[12:15], 0 offen
    s_or_b64 exec, s[36:37], s[38:39]
    buffer_load_dwordx3 v[52:54], v30, s[12:15], 0 offen
    s_mov_b64 exec, -1
    ds_bpermute_b32 v32, v91, v12 offset:64
    ds_bpermute_b32 v33, v91, v11 offset:64
    ds_bpermute_b32 v34, v91, v12 offset:80
    ds_bpermute_b32 v35, v91, v11 offset:80
    ds_bpermute_b32 v36, v91, v12 offset:96
    ds_bpermute_b32 v37, v91, v11 offset:96
    ds_bpermute_b32 v38, v91, v12 offset:112
    ds_bpermute_b32 v39, v91, v11 offset:112
    s_waitcnt lgkmcnt(0)
    v_lshlrev_b32 v9, v93, v33
    v_lshlrev_b32 v10, v94, v33
    v_add_u32 v32, v32, v92
    v_cmp_gt_i32 s[40:41], 0, v9
    v_cmp_gt_i32 s[42:43], 0, v10
    v_lshlrev_b32 v9, v93, v35
    v_lshlrev_b32 v10, v94, v35
    v_add_u32 v34, v34, v92
    v_cmp_gt_i32 s[44:45], 0, v9
    v_cmp_gt_i32 s[46:47], 0, v10
    v_lshlrev_b32 v9, v93, v37
    v_lshlrev_b32 v10, v94, v37
    v_add_u32 v36, v36, v92
    v_cmp_gt_i32 s[48:49], 0, v9
    v_cmp_gt_i32 s[50:51], 0, v10
    v_lshlrev_b32 v9, v93, v39
    v_lshlrev_b32 v10, v94, v39
    v_add_u32 v38, v38, v92
    v_cmp_gt_i32 s[52:53], 0, v9
    v_cmp_gt_i32 s[54:55], 0, v10
    s_or_b64 exec, s[40:41], s[42:43]
    buffer_load_dwordx3 v[56:58], v32, s[12:15], 0 offen
    s_or_b64 exec, s[44:45], s[46:47]
    buffer_load_dwordx3 v[60:62], v34, s[12:15], 0 offen
    s_or_b64 exec, s[48:49], s[50:51]
    buffer_load_dwordx3 v[64:66], v36, s[12:15], 0 offen
    s_or_b64 exec, s[52:53], s[54:55]
    buffer_load_dwordx3 v[68:70], v38, s[12:15], 0 offen
    s_mov_b64 exec, -1
K2_pnoload:
    v_add_u32 v5, s61, v5
    v_add_u32 v6, s62, v6
    s_sub_u32 s61, 0, s61
    s_sub_u32 s62, 0, s62
    s_add_u32 s63, s63, 1
    s_cmp_lt_u32 s63, 4
    s_cbranch_scc1 K2_ploop
    s_load_dwordx2 s[8:9], s[0:1], 24
    s_load_dwordx2 s[10:11], s[0:1], 40
    s_load_dwordx4 s[12:15], s[0:1], 56
    s_load_dwordx4 s[16:19], s[0:1], 80
    s_load_dwordx2 s[20:21], s[0:1], 72
    v_and_b32 v2, 15, v1
    v_lshrrev_b32 v3, 4, v1
    v_lshlrev_b32 v5, 4, v1
    s_and_b32 s48, s2, 7
    s_lshl_b32 s48, s48, 5
    s_lshr_b32 s49, s2, 3
    s_add_u32 s49, s49, s48
    s_lshl_b32 s49, s49, 4
    s_lshl_b32 s48, s3, 12
    s_add_u32 s48, s48, s49
    v_add_u32 v7, s48, v2
    v_lshlrev_b32 v4, 5, v7
    v_lshl_add_u32 v4, v3, 3, v4
    v_lshlrev_b32 v7, 1, v7
    v_lshlrev_b32 v6, 7, v3
    v_lshl_add_u32 v6, v2, 1, v6
    v_lshlrev_b32 v20, 3, v3
    s_waitcnt lgkmcnt(0)
    s_mov_b32 s44, s8
    s_mov_b32 s45, s9
    s_mov_b32 s46, 800000
    s_mov_b32 s47, 0x20000
    s_mov_b32 s48, 0
    buffer_load_ushort v24, v7, s[44:47], s48 offen
    s_mov_b32 s48, 65536
    buffer_load_ushort v25, v7, s[44:47], s48 offen
    s_mov_b32 s48, 131072
    buffer_load_ushort v26, v7, s[44:47], s48 offen
    s_mov_b32 s48, 196608
    buffer_load_ushort v27, v7, s[44:47], s48 offen
    s_mov_b32 s48, 262144
    buffer_load_ushort v28, v7, s[44:47], s48 offen
    s_mov_b32 s48, 327680
    buffer_load_ushort v29, v7, s[44:47], s48 offen
    s_mov_b32 s48, 393216
    buffer_load_ushort v30, v7, s[44:47], s48 offen
    s_mov_b32 s48, 458752
    buffer_load_ushort v31, v7, s[44:47], s48 offen
    s_mov_b32 s48, 524288
    buffer_load_ushort v32, v7, s[44:47], s48 offen
    s_mov_b32 s48, 589824
    buffer_load_ushort v33, v7, s[44:47], s48 offen
    s_mov_b32 s48, 655360
    buffer_load_ushort v34, v7, s[44:47], s48 offen
    s_mov_b32 s48, 720896
    buffer_load_ushort v35, v7, s[44:47], s48 offen
    s_mov_b32 s48, 786432
    buffer_load_ushort v36, v7, s[44:47], s48 offen
    s_mov_b32 s28, s10
    s_mov_b32 s29, s11
    s_mov_b32 s30, 16
    s_mov_b32 s31, 0x20000
    buffer_load_ushort v98, v20, s[28:31], 0 offen offset:0
    buffer_load_ushort v99, v20, s[28:31], 0 offen offset:2
    buffer_load_ushort v100, v20, s[28:31], 0 offen offset:4
    buffer_load_ushort v101, v20, s[28:31], 0 offen offset:6
    s_mov_b32 s32, s14
    s_mov_b32 s33, s15
    s_mov_b32 s34, 256
    s_mov_b32 s35, 0x20000
    buffer_load_ushort v8, v6, s[32:35], 0 offen offset:0
    buffer_load_ushort v9, v6, s[32:35], 0 offen offset:32
    buffer_load_ushort v10, v6, s[32:35], 0 offen offset:64
    buffer_load_ushort v11, v6, s[32:35], 0 offen offset:96
    s_mov_b32 s36, s12
    s_mov_b32 s37, s13
    s_mov_b32 s38, 256
    s_mov_b32 s39, 0x20000
    buffer_load_ushort v12, v6, s[36:39], 0 offen offset:0
    buffer_load_ushort v13, v6, s[36:39], 0 offen offset:32
    buffer_load_ushort v14, v6, s[36:39], 0 offen offset:64
    buffer_load_ushort v15, v6, s[36:39], 0 offen offset:96
    s_mov_b32 s40, s16
    s_mov_b32 s41, s17
    s_mov_b32 s42, 512
    s_mov_b32 s43, 0x20000
    buffer_load_ushort v16, v6, s[40:43], 0 offen offset:0
    buffer_load_ushort v17, v6, s[40:43], 0 offen offset:32
    buffer_load_ushort v18, v6, s[40:43], 0 offen offset:64
    buffer_load_ushort v19, v6, s[40:43], 0 offen offset:96
    s_mov_b32 s24, s4
    s_mov_b32 s25, s5
    s_mov_b32 s26, 12800000
    s_mov_b32 s27, 0x20000
    s_mov_b32 s48, 0
    buffer_load_dwordx2 v[40:41], v4, s[24:27], s48 offen
    s_mov_b32 s48, 1048576
    buffer_load_dwordx2 v[42:43], v4, s[24:27], s48 offen
    s_mov_b32 s48, 2097152
    buffer_load_dwordx2 v[44:45], v4, s[24:27], s48 offen
    s_mov_b32 s48, 3145728
    buffer_load_dwordx2 v[46:47], v4, s[24:27], s48 offen
    s_mov_b32 s48, 4194304
    buffer_load_dwordx2 v[48:49], v4, s[24:27], s48 offen
    s_mov_b32 s48, 5242880
    buffer_load_dwordx2 v[50:51], v4, s[24:27], s48 offen
    s_mov_b32 s48, 6291456
    buffer_load_dwordx2 v[52:53], v4, s[24:27], s48 offen
    s_mov_b32 s48, 7340032
    buffer_load_dwordx2 v[54:55], v4, s[24:27], s48 offen
    s_mov_b32 s48, 8388608
    buffer_load_dwordx2 v[56:57], v4, s[24:27], s48 offen
    s_mov_b32 s48, 9437184
    buffer_load_dwordx2 v[58:59], v4, s[24:27], s48 offen
    s_mov_b32 s48, 10485760
    buffer_load_dwordx2 v[60:61], v4, s[24:27], s48 offen
    s_mov_b32 s48, 11534336
    buffer_load_dwordx2 v[62:63], v4, s[24:27], s48 offen
    s_mov_b32 s48, 12582912
    buffer_load_dwordx2 v[64:65], v4, s[24:27], s48 offen
    s_mov_b32 s44, s18
    s_mov_b32 s45, s19
    s_mov_b32 s46, 12800000
    s_mov_b32 s47, 0x20000
    s_mov_b32 s50, 0xffff0000
    s_mov_b32 s51, 0xc1200000
    s_mov_b32 s52, 0x3fb8aa3b
    s_waitcnt vmcnt(13)
    v_lshl_or_b32 v92, v9, 16, v8
    v_lshl_or_b32 v93, v11, 16, v10
    v_lshl_or_b32 v94, v13, 16, v12
    v_lshl_or_b32 v95, v15, 16, v14
    v_lshl_or_b32 v96, v17, 16, v16
    v_lshl_or_b32 v97, v19, 16, v18
    v_lshlrev_b32 v98, 16, v98
    v_lshlrev_b32 v99, 16, v99
    v_lshlrev_b32 v100, 16, v100
    v_lshlrev_b32 v101, 16, v101
    v_lshlrev_b32 v7, 16, v24
    v_sub_f32 v102, v7, v98
    v_sub_f32 v103, v7, v99
    v_cvt_pk_bf16_f32 v104, v102, v103
    v_lshlrev_b32 v102, 16, v104
    v_and_b32 v103, s50, v104
    v_mul_f32 v102, v102, v102
    v_mul_f32 v103, v103, v103
    v_cvt_pk_bf16_f32 v104, v102, v103
    v_lshlrev_b32 v102, 16, v104
    v_and_b32 v103, s50, v104
    v_mul_f32 v102, s51, v102
    v_mul_f32 v103, s51, v103
    v_cvt_pk_bf16_f32 v104, v102, v103
    v_lshlrev_b32 v102, 16, v104
    v_and_b32 v103, s50, v104
    v_mul_f32 v102, s52, v102
    v_mul_f32 v103, s52, v103
    v_exp_f32 v102, v102
    v_exp_f32 v103, v103
    s_nop 0
    v_cvt_pk_bf16_f32 v114, v102, v103
    v_sub_f32 v102, v7, v100
    v_sub_f32 v103, v7, v101
    v_cvt_pk_bf16_f32 v104, v102, v103
    v_lshlrev_b32 v102, 16, v104
    v_and_b32 v103, s50, v104
    v_mul_f32 v102, v102, v102
    v_mul_f32 v103, v103, v103
    v_cvt_pk_bf16_f32 v104, v102, v103
    v_lshlrev_b32 v102, 16, v104
    v_and_b32 v103, s50, v104
    v_mul_f32 v102, s51, v102
    v_mul_f32 v103, s51, v103
    v_cvt_pk_bf16_f32 v104, v102, v103
    v_lshlrev_b32 v102, 16, v104
    v_and_b32 v103, s50, v104
    v_mul_f32 v102, s52, v102
    v_mul_f32 v103, s52, v103
    v_exp_f32 v102, v102
    v_exp_f32 v103, v103
    s_nop 0
    v_cvt_pk_bf16_f32 v115, v102, v103
    s_nop 1
    v_mfma_f32_16x16x16_bf16 v[106:109], v[92:93], v[114:115], 0
    v_mfma_f32_16x16x16_bf16 v[110:113], v[94:95], v[114:115], 0
    s_nop 7
    v_cvt_pk_bf16_f32 v66, v106, v107
    v_cvt_pk_bf16_f32 v67, v108, v109
    v_cvt_pk_bf16_f32 v8, v110, v111
    v_cvt_pk_bf16_f32 v9, v112, v113
    v_lshlrev_b32 v7, 16, v25
    v_sub_f32 v102, v7, v98
    v_sub_f32 v103, v7, v99
    v_cvt_pk_bf16_f32 v104, v102, v103
    v_lshlrev_b32 v102, 16, v104
    v_and_b32 v103, s50, v104
    v_mul_f32 v102, v102, v102
    v_mul_f32 v103, v103, v103
    v_cvt_pk_bf16_f32 v104, v102, v103
    v_lshlrev_b32 v102, 16, v104
    v_and_b32 v103, s50, v104
    v_mul_f32 v102, s51, v102
    v_mul_f32 v103, s51, v103
    v_cvt_pk_bf16_f32 v104, v102, v103
    v_lshlrev_b32 v102, 16, v104
    v_and_b32 v103, s50, v104
    v_mul_f32 v102, s52, v102
    v_mul_f32 v103, s52, v103
    v_exp_f32 v102, v102
    v_exp_f32 v103, v103
    s_nop 0
    v_cvt_pk_bf16_f32 v114, v102, v103
    v_sub_f32 v102, v7, v100
    v_sub_f32 v103, v7, v101
    v_cvt_pk_bf16_f32 v104, v102, v103
    v_lshlrev_b32 v102, 16, v104
    v_and_b32 v103, s50, v104
    v_mul_f32 v102, v102, v102
    v_mul_f32 v103, v103, v103
    v_cvt_pk_bf16_f32 v104, v102, v103
    v_lshlrev_b32 v102, 16, v104
    v_and_b32 v103, s50, v104
    v_mul_f32 v102, s51, v102
    v_mul_f32 v103, s51, v103
    v_cvt_pk_bf16_f32 v104, v102, v103
    v_lshlrev_b32 v102, 16, v104
    v_and_b32 v103, s50, v104
    v_mul_f32 v102, s52, v102
    v_mul_f32 v103, s52, v103
    v_exp_f32 v102, v102
    v_exp_f32 v103, v103
    s_nop 0
    v_cvt_pk_bf16_f32 v115, v102, v103
    s_nop 1
    v_mfma_f32_16x16x16_bf16 v[106:109], v[92:93], v[114:115], 0
    v_mfma_f32_16x16x16_bf16 v[110:113], v[94:95], v[114:115], 0
    s_nop 7
    v_cvt_pk_bf16_f32 v68, v106, v107
    v_cvt_pk_bf16_f32 v69, v108, v109
    v_cvt_pk_bf16_f32 v10, v110, v111
    v_cvt_pk_bf16_f32 v11, v112, v113
    v_lshlrev_b32 v7, 16, v26
    v_sub_f32 v102, v7, v98
    v_sub_f32 v103, v7, v99
    v_cvt_pk_bf16_f32 v104, v102, v103
    v_lshlrev_b32 v102, 16, v104
    v_and_b32 v103, s50, v104
    v_mul_f32 v102, v102, v102
    v_mul_f32 v103, v103, v103
    v_cvt_pk_bf16_f32 v104, v102, v103
    v_lshlrev_b32 v102, 16, v104
    v_and_b32 v103, s50, v104
    v_mul_f32 v102, s51, v102
    v_mul_f32 v103, s51, v103
    v_cvt_pk_bf16_f32 v104, v102, v103
    v_lshlrev_b32 v102, 16, v104
    v_and_b32 v103, s50, v104
    v_mul_f32 v102, s52, v102
    v_mul_f32 v103, s52, v103
    v_exp_f32 v102, v102
    v_exp_f32 v103, v103
    s_nop 0
    v_cvt_pk_bf16_f32 v114, v102, v103
    v_sub_f32 v102, v7, v100
    v_sub_f32 v103, v7, v101
    v_cvt_pk_bf16_f32 v104, v102, v103
    v_lshlrev_b32 v102, 16, v104
    v_and_b32 v103, s50, v104
    v_mul_f32 v102, v102, v102
    v_mul_f32 v103, v103, v103
    v_cvt_pk_bf16_f32 v104, v102, v103
    v_lshlrev_b32 v102, 16, v104
    v_and_b32 v103, s50, v104
    v_mul_f32 v102, s51, v102
    v_mul_f32 v103, s51, v103
    v_cvt_pk_bf16_f32 v104, v102, v103
    v_lshlrev_b32 v102, 16, v104
    v_and_b32 v103, s50, v104
    v_mul_f32 v102, s52, v102
    v_mul_f32 v103, s52, v103
    v_exp_f32 v102, v102
    v_exp_f32 v103, v103
    s_nop 0
    v_cvt_pk_bf16_f32 v115, v102, v103
    s_nop 1
    v_mfma_f32_16x16x16_bf16 v[106:109], v[92:93], v[114:115], 0
    v_mfma_f32_16x16x16_bf16 v[110:113], v[94:95], v[114:115], 0
    s_nop 7
    v_cvt_pk_bf16_f32 v70, v106, v107
    v_cvt_pk_bf16_f32 v71, v108, v109
    v_cvt_pk_bf16_f32 v12, v110, v111
    v_cvt_pk_bf16_f32 v13, v112, v113
    v_lshlrev_b32 v7, 16, v27
    v_sub_f32 v102, v7, v98
    v_sub_f32 v103, v7, v99
    v_cvt_pk_bf16_f32 v104, v102, v103
    v_lshlrev_b32 v102, 16, v104
    v_and_b32 v103, s50, v104
    v_mul_f32 v102, v102, v102
    v_mul_f32 v103, v103, v103
    v_cvt_pk_bf16_f32 v104, v102, v103
    v_lshlrev_b32 v102, 16, v104
    v_and_b32 v103, s50, v104
    v_mul_f32 v102, s51, v102
    v_mul_f32 v103, s51, v103
    v_cvt_pk_bf16_f32 v104, v102, v103
    v_lshlrev_b32 v102, 16, v104
    v_and_b32 v103, s50, v104
    v_mul_f32 v102, s52, v102
    v_mul_f32 v103, s52, v103
    v_exp_f32 v102, v102
    v_exp_f32 v103, v103
    s_nop 0
    v_cvt_pk_bf16_f32 v114, v102, v103
    v_sub_f32 v102, v7, v100
    v_sub_f32 v103, v7, v101
    v_cvt_pk_bf16_f32 v104, v102, v103
    v_lshlrev_b32 v102, 16, v104
    v_and_b32 v103, s50, v104
    v_mul_f32 v102, v102, v102
    v_mul_f32 v103, v103, v103
    v_cvt_pk_bf16_f32 v104, v102, v103
    v_lshlrev_b32 v102, 16, v104
    v_and_b32 v103, s50, v104
    v_mul_f32 v102, s51, v102
    v_mul_f32 v103, s51, v103
    v_cvt_pk_bf16_f32 v104, v102, v103
    v_lshlrev_b32 v102, 16, v104
    v_and_b32 v103, s50, v104
    v_mul_f32 v102, s52, v102
    v_mul_f32 v103, s52, v103
    v_exp_f32 v102, v102
    v_exp_f32 v103, v103
    s_nop 0
    v_cvt_pk_bf16_f32 v115, v102, v103
    s_nop 1
    v_mfma_f32_16x16x16_bf16 v[106:109], v[92:93], v[114:115], 0
    v_mfma_f32_16x16x16_bf16 v[110:113], v[94:95], v[114:115], 0
    s_nop 7
    v_cvt_pk_bf16_f32 v72, v106, v107
    v_cvt_pk_bf16_f32 v73, v108, v109
    v_cvt_pk_bf16_f32 v14, v110, v111
    v_cvt_pk_bf16_f32 v15, v112, v113
    v_lshlrev_b32 v7, 16, v28
    v_sub_f32 v102, v7, v98
    v_sub_f32 v103, v7, v99
    v_cvt_pk_bf16_f32 v104, v102, v103
    v_lshlrev_b32 v102, 16, v104
    v_and_b32 v103, s50, v104
    v_mul_f32 v102, v102, v102
    v_mul_f32 v103, v103, v103
    v_cvt_pk_bf16_f32 v104, v102, v103
    v_lshlrev_b32 v102, 16, v104
    v_and_b32 v103, s50, v104
    v_mul_f32 v102, s51, v102
    v_mul_f32 v103, s51, v103
    v_cvt_pk_bf16_f32 v104, v102, v103
    v_lshlrev_b32 v102, 16, v104
    v_and_b32 v103, s50, v104
    v_mul_f32 v102, s52, v102
    v_mul_f32 v103, s52, v103
    v_exp_f32 v102, v102
    v_exp_f32 v103, v103
    s_nop 0
    v_cvt_pk_bf16_f32 v114, v102, v103
    v_sub_f32 v102, v7, v100
    v_sub_f32 v103, v7, v101
    v_cvt_pk_bf16_f32 v104, v102, v103
    v_lshlrev_b32 v102, 16, v104
    v_and_b32 v103, s50, v104
    v_mul_f32 v102, v102, v102
    v_mul_f32 v103, v103, v103
    v_cvt_pk_bf16_f32 v104, v102, v103
    v_lshlrev_b32 v102, 16, v104
    v_and_b32 v103, s50, v104
    v_mul_f32 v102, s51, v102
    v_mul_f32 v103, s51, v103
    v_cvt_pk_bf16_f32 v104, v102, v103
    v_lshlrev_b32 v102, 16, v104
    v_and_b32 v103, s50, v104
    v_mul_f32 v102, s52, v102
    v_mul_f32 v103, s52, v103
    v_exp_f32 v102, v102
    v_exp_f32 v103, v103
    s_nop 0
    v_cvt_pk_bf16_f32 v115, v102, v103
    s_nop 1
    v_mfma_f32_16x16x16_bf16 v[106:109], v[92:93], v[114:115], 0
    v_mfma_f32_16x16x16_bf16 v[110:113], v[94:95], v[114:115], 0
    s_nop 7
    v_cvt_pk_bf16_f32 v74, v106, v107
    v_cvt_pk_bf16_f32 v75, v108, v109
    v_cvt_pk_bf16_f32 v16, v110, v111
    v_cvt_pk_bf16_f32 v17, v112, v113
    v_lshlrev_b32 v7, 16, v29
    v_sub_f32 v102, v7, v98
    v_sub_f32 v103, v7, v99
    v_cvt_pk_bf16_f32 v104, v102, v103
    v_lshlrev_b32 v102, 16, v104
    v_and_b32 v103, s50, v104
    v_mul_f32 v102, v102, v102
    v_mul_f32 v103, v103, v103
    v_cvt_pk_bf16_f32 v104, v102, v103
    v_lshlrev_b32 v102, 16, v104
    v_and_b32 v103, s50, v104
    v_mul_f32 v102, s51, v102
    v_mul_f32 v103, s51, v103
    v_cvt_pk_bf16_f32 v104, v102, v103
    v_lshlrev_b32 v102, 16, v104
    v_and_b32 v103, s50, v104
    v_mul_f32 v102, s52, v102
    v_mul_f32 v103, s52, v103
    v_exp_f32 v102, v102
    v_exp_f32 v103, v103
    s_nop 0
    v_cvt_pk_bf16_f32 v114, v102, v103
    v_sub_f32 v102, v7, v100
    v_sub_f32 v103, v7, v101
    v_cvt_pk_bf16_f32 v104, v102, v103
    v_lshlrev_b32 v102, 16, v104
    v_and_b32 v103, s50, v104
    v_mul_f32 v102, v102, v102
    v_mul_f32 v103, v103, v103
    v_cvt_pk_bf16_f32 v104, v102, v103
    v_lshlrev_b32 v102, 16, v104
    v_and_b32 v103, s50, v104
    v_mul_f32 v102, s51, v102
    v_mul_f32 v103, s51, v103
    v_cvt_pk_bf16_f32 v104, v102, v103
    v_lshlrev_b32 v102, 16, v104
    v_and_b32 v103, s50, v104
    v_mul_f32 v102, s52, v102
    v_mul_f32 v103, s52, v103
    v_exp_f32 v102, v102
    v_exp_f32 v103, v103
    s_nop 0
    v_cvt_pk_bf16_f32 v115, v102, v103
    s_nop 1
    v_mfma_f32_16x16x16_bf16 v[106:109], v[92:93], v[114:115], 0
    v_mfma_f32_16x16x16_bf16 v[110:113], v[94:95], v[114:115], 0
    s_nop 7
    v_cvt_pk_bf16_f32 v76, v106, v107
    v_cvt_pk_bf16_f32 v77, v108, v109
    v_cvt_pk_bf16_f32 v18, v110, v111
    v_cvt_pk_bf16_f32 v19, v112, v113
    v_lshlrev_b32 v7, 16, v30
    v_sub_f32 v102, v7, v98
    v_sub_f32 v103, v7, v99
    v_cvt_pk_bf16_f32 v104, v102, v103
    v_lshlrev_b32 v102, 16, v104
    v_and_b32 v103, s50, v104
    v_mul_f32 v102, v102, v102
    v_mul_f32 v103, v103, v103
    v_cvt_pk_bf16_f32 v104, v102, v103
    v_lshlrev_b32 v102, 16, v104
    v_and_b32 v103, s50, v104
    v_mul_f32 v102, s51, v102
    v_mul_f32 v103, s51, v103
    v_cvt_pk_bf16_f32 v104, v102, v103
    v_lshlrev_b32 v102, 16, v104
    v_and_b32 v103, s50, v104
    v_mul_f32 v102, s52, v102
    v_mul_f32 v103, s52, v103
    v_exp_f32 v102, v102
    v_exp_f32 v103, v103
    s_nop 0
    v_cvt_pk_bf16_f32 v114, v102, v103
    v_sub_f32 v102, v7, v100
    v_sub_f32 v103, v7, v101
    v_cvt_pk_bf16_f32 v104, v102, v103
    v_lshlrev_b32 v102, 16, v104
    v_and_b32 v103, s50, v104
    v_mul_f32 v102, v102, v102
    v_mul_f32 v103, v103, v103
    v_cvt_pk_bf16_f32 v104, v102, v103
    v_lshlrev_b32 v102, 16, v104
    v_and_b32 v103, s50, v104
    v_mul_f32 v102, s51, v102
    v_mul_f32 v103, s51, v103
    v_cvt_pk_bf16_f32 v104, v102, v103
    v_lshlrev_b32 v102, 16, v104
    v_and_b32 v103, s50, v104
    v_mul_f32 v102, s52, v102
    v_mul_f32 v103, s52, v103
    v_exp_f32 v102, v102
    v_exp_f32 v103, v103
    s_nop 0
    v_cvt_pk_bf16_f32 v115, v102, v103
    s_nop 1
    v_mfma_f32_16x16x16_bf16 v[106:109], v[92:93], v[114:115], 0
    v_mfma_f32_16x16x16_bf16 v[110:113], v[94:95], v[114:115], 0
    s_nop 7
    v_cvt_pk_bf16_f32 v78, v106, v107
    v_cvt_pk_bf16_f32 v79, v108, v109
    v_cvt_pk_bf16_f32 v20, v110, v111
    v_cvt_pk_bf16_f32 v21, v112, v113
    v_lshlrev_b32 v7, 16, v31
    v_sub_f32 v102, v7, v98
    v_sub_f32 v103, v7, v99
    v_cvt_pk_bf16_f32 v104, v102, v103
    v_lshlrev_b32 v102, 16, v104
    v_and_b32 v103, s50, v104
    v_mul_f32 v102, v102, v102
    v_mul_f32 v103, v103, v103
    v_cvt_pk_bf16_f32 v104, v102, v103
    v_lshlrev_b32 v102, 16, v104
    v_and_b32 v103, s50, v104
    v_mul_f32 v102, s51, v102
    v_mul_f32 v103, s51, v103
    v_cvt_pk_bf16_f32 v104, v102, v103
    v_lshlrev_b32 v102, 16, v104
    v_and_b32 v103, s50, v104
    v_mul_f32 v102, s52, v102
    v_mul_f32 v103, s52, v103
    v_exp_f32 v102, v102
    v_exp_f32 v103, v103
    s_nop 0
    v_cvt_pk_bf16_f32 v114, v102, v103
    v_sub_f32 v102, v7, v100
    v_sub_f32 v103, v7, v101
    v_cvt_pk_bf16_f32 v104, v102, v103
    v_lshlrev_b32 v102, 16, v104
    v_and_b32 v103, s50, v104
    v_mul_f32 v102, v102, v102
    v_mul_f32 v103, v103, v103
    v_cvt_pk_bf16_f32 v104, v102, v103
    v_lshlrev_b32 v102, 16, v104
    v_and_b32 v103, s50, v104
    v_mul_f32 v102, s51, v102
    v_mul_f32 v103, s51, v103
    v_cvt_pk_bf16_f32 v104, v102, v103
    v_lshlrev_b32 v102, 16, v104
    v_and_b32 v103, s50, v104
    v_mul_f32 v102, s52, v102
    v_mul_f32 v103, s52, v103
    v_exp_f32 v102, v102
    v_exp_f32 v103, v103
    s_nop 0
    v_cvt_pk_bf16_f32 v115, v102, v103
    s_nop 1
    v_mfma_f32_16x16x16_bf16 v[106:109], v[92:93], v[114:115], 0
    v_mfma_f32_16x16x16_bf16 v[110:113], v[94:95], v[114:115], 0
    s_nop 7
    v_cvt_pk_bf16_f32 v80, v106, v107
    v_cvt_pk_bf16_f32 v81, v108, v109
    v_cvt_pk_bf16_f32 v22, v110, v111
    v_cvt_pk_bf16_f32 v23, v112, v113
    v_lshlrev_b32 v7, 16, v32
    v_sub_f32 v102, v7, v98
    v_sub_f32 v103, v7, v99
    v_cvt_pk_bf16_f32 v104, v102, v103
    v_lshlrev_b32 v102, 16, v104
    v_and_b32 v103, s50, v104
    v_mul_f32 v102, v102, v102
    v_mul_f32 v103, v103, v103
    v_cvt_pk_bf16_f32 v104, v102, v103
    v_lshlrev_b32 v102, 16, v104
    v_and_b32 v103, s50, v104
    v_mul_f32 v102, s51, v102
    v_mul_f32 v103, s51, v103
    v_cvt_pk_bf16_f32 v104, v102, v103
    v_lshlrev_b32 v102, 16, v104
    v_and_b32 v103, s50, v104
    v_mul_f32 v102, s52, v102
    v_mul_f32 v103, s52, v103
    v_exp_f32 v102, v102
    v_exp_f32 v103, v103
    s_nop 0
    v_cvt_pk_bf16_f32 v114, v102, v103
    v_sub_f32 v102, v7, v100
    v_sub_f32 v103, v7, v101
    v_cvt_pk_bf16_f32 v104, v102, v103
    v_lshlrev_b32 v102, 16, v104
    v_and_b32 v103, s50, v104
    v_mul_f32 v102, v102, v102
    v_mul_f32 v103, v103, v103
    v_cvt_pk_bf16_f32 v104, v102, v103
    v_lshlrev_b32 v102, 16, v104
    v_and_b32 v103, s50, v104
    v_mul_f32 v102, s51, v102
    v_mul_f32 v103, s51, v103
    v_cvt_pk_bf16_f32 v104, v102, v103
    v_lshlrev_b32 v102, 16, v104
    v_and_b32 v103, s50, v104
    v_mul_f32 v102, s52, v102
    v_mul_f32 v103, s52, v103
    v_exp_f32 v102, v102
    v_exp_f32 v103, v103
    s_nop 0
    v_cvt_pk_bf16_f32 v115, v102, v103
    s_nop 1
    v_mfma_f32_16x16x16_bf16 v[106:109], v[92:93], v[114:115], 0
    v_mfma_f32_16x16x16_bf16 v[110:113], v[94:95], v[114:115], 0
    s_nop 7
    v_cvt_pk_bf16_f32 v82, v106, v107
    v_cvt_pk_bf16_f32 v83, v108, v109
    v_cvt_pk_bf16_f32 v24, v110, v111
    v_cvt_pk_bf16_f32 v25, v112, v113
    v_lshlrev_b32 v7, 16, v33
    v_sub_f32 v102, v7, v98
    v_sub_f32 v103, v7, v99
    v_cvt_pk_bf16_f32 v104, v102, v103
    v_lshlrev_b32 v102, 16, v104
    v_and_b32 v103, s50, v104
    v_mul_f32 v102, v102, v102
    v_mul_f32 v103, v103, v103
    v_cvt_pk_bf16_f32 v104, v102, v103
    v_lshlrev_b32 v102, 16, v104
    v_and_b32 v103, s50, v104
    v_mul_f32 v102, s51, v102
    v_mul_f32 v103, s51, v103
    v_cvt_pk_bf16_f32 v104, v102, v103
    v_lshlrev_b32 v102, 16, v104
    v_and_b32 v103, s50, v104
    v_mul_f32 v102, s52, v102
    v_mul_f32 v103, s52, v103
    v_exp_f32 v102, v102
    v_exp_f32 v103, v103
    s_nop 0
    v_cvt_pk_bf16_f32 v114, v102, v103
    v_sub_f32 v102, v7, v100
    v_sub_f32 v103, v7, v101
    v_cvt_pk_bf16_f32 v104, v102, v103
    v_lshlrev_b32 v102, 16, v104
    v_and_b32 v103, s50, v104
    v_mul_f32 v102, v102, v102
    v_mul_f32 v103, v103, v103
    v_cvt_pk_bf16_f32 v104, v102, v103
    v_lshlrev_b32 v102, 16, v104
    v_and_b32 v103, s50, v104
    v_mul_f32 v102, s51, v102
    v_mul_f32 v103, s51, v103
    v_cvt_pk_bf16_f32 v104, v102, v103
    v_lshlrev_b32 v102, 16, v104
    v_and_b32 v103, s50, v104
    v_mul_f32 v102, s52, v102
    v_mul_f32 v103, s52, v103
    v_exp_f32 v102, v102
    v_exp_f32 v103, v103
    s_nop 0
    v_cvt_pk_bf16_f32 v115, v102, v103
    s_nop 1
    v_mfma_f32_16x16x16_bf16 v[106:109], v[92:93], v[114:115], 0
    v_mfma_f32_16x16x16_bf16 v[110:113], v[94:95], v[114:115], 0
    s_nop 7
    v_cvt_pk_bf16_f32 v84, v106, v107
    v_cvt_pk_bf16_f32 v85, v108, v109
    v_cvt_pk_bf16_f32 v26, v110, v111
    v_cvt_pk_bf16_f32 v27, v112, v113
    v_lshlrev_b32 v7, 16, v34
    v_sub_f32 v102, v7, v98
    v_sub_f32 v103, v7, v99
    v_cvt_pk_bf16_f32 v104, v102, v103
    v_lshlrev_b32 v102, 16, v104
    v_and_b32 v103, s50, v104
    v_mul_f32 v102, v102, v102
    v_mul_f32 v103, v103, v103
    v_cvt_pk_bf16_f32 v104, v102, v103
    v_lshlrev_b32 v102, 16, v104
    v_and_b32 v103, s50, v104
    v_mul_f32 v102, s51, v102
    v_mul_f32 v103, s51, v103
    v_cvt_pk_bf16_f32 v104, v102, v103
    v_lshlrev_b32 v102, 16, v104
    v_and_b32 v103, s50, v104
    v_mul_f32 v102, s52, v102
    v_mul_f32 v103, s52, v103
    v_exp_f32 v102, v102
    v_exp_f32 v103, v103
    s_nop 0
    v_cvt_pk_bf16_f32 v114, v102, v103
    v_sub_f32 v102, v7, v100
    v_sub_f32 v103, v7, v101
    v_cvt_pk_bf16_f32 v104, v102, v103
    v_lshlrev_b32 v102, 16, v104
    v_and_b32 v103, s50, v104
    v_mul_f32 v102, v102, v102
    v_mul_f32 v103, v103, v103
    v_cvt_pk_bf16_f32 v104, v102, v103
    v_lshlrev_b32 v102, 16, v104
    v_and_b32 v103, s50, v104
    v_mul_f32 v102, s51, v102
    v_mul_f32 v103, s51, v103
    v_cvt_pk_bf16_f32 v104, v102, v103
    v_lshlrev_b32 v102, 16, v104
    v_and_b32 v103, s50, v104
    v_mul_f32 v102, s52, v102
    v_mul_f32 v103, s52, v103
    v_exp_f32 v102, v102
    v_exp_f32 v103, v103
    s_nop 0
    v_cvt_pk_bf16_f32 v115, v102, v103
    s_nop 1
    v_mfma_f32_16x16x16_bf16 v[106:109], v[92:93], v[114:115], 0
    v_mfma_f32_16x16x16_bf16 v[110:113], v[94:95], v[114:115], 0
    s_nop 7
    v_cvt_pk_bf16_f32 v86, v106, v107
    v_cvt_pk_bf16_f32 v87, v108, v109
    v_cvt_pk_bf16_f32 v28, v110, v111
    v_cvt_pk_bf16_f32 v29, v112, v113
    v_lshlrev_b32 v7, 16, v35
    v_sub_f32 v102, v7, v98
    v_sub_f32 v103, v7, v99
    v_cvt_pk_bf16_f32 v104, v102, v103
    v_lshlrev_b32 v102, 16, v104
    v_and_b32 v103, s50, v104
    v_mul_f32 v102, v102, v102
    v_mul_f32 v103, v103, v103
    v_cvt_pk_bf16_f32 v104, v102, v103
    v_lshlrev_b32 v102, 16, v104
    v_and_b32 v103, s50, v104
    v_mul_f32 v102, s51, v102
    v_mul_f32 v103, s51, v103
    v_cvt_pk_bf16_f32 v104, v102, v103
    v_lshlrev_b32 v102, 16, v104
    v_and_b32 v103, s50, v104
    v_mul_f32 v102, s52, v102
    v_mul_f32 v103, s52, v103
    v_exp_f32 v102, v102
    v_exp_f32 v103, v103
    s_nop 0
    v_cvt_pk_bf16_f32 v114, v102, v103
    v_sub_f32 v102, v7, v100
    v_sub_f32 v103, v7, v101
    v_cvt_pk_bf16_f32 v104, v102, v103
    v_lshlrev_b32 v102, 16, v104
    v_and_b32 v103, s50, v104
    v_mul_f32 v102, v102, v102
    v_mul_f32 v103, v103, v103
    v_cvt_pk_bf16_f32 v104, v102, v103
    v_lshlrev_b32 v102, 16, v104
    v_and_b32 v103, s50, v104
    v_mul_f32 v102, s51, v102
    v_mul_f32 v103, s51, v103
    v_cvt_pk_bf16_f32 v104, v102, v103
    v_lshlrev_b32 v102, 16, v104
    v_and_b32 v103, s50, v104
    v_mul_f32 v102, s52, v102
    v_mul_f32 v103, s52, v103
    v_exp_f32 v102, v102
    v_exp_f32 v103, v103
    s_nop 0
    v_cvt_pk_bf16_f32 v115, v102, v103
    s_nop 1
    v_mfma_f32_16x16x16_bf16 v[106:109], v[92:93], v[114:115], 0
    v_mfma_f32_16x16x16_bf16 v[110:113], v[94:95], v[114:115], 0
    s_nop 7
    v_cvt_pk_bf16_f32 v88, v106, v107
    v_cvt_pk_bf16_f32 v89, v108, v109
    v_cvt_pk_bf16_f32 v30, v110, v111
    v_cvt_pk_bf16_f32 v31, v112, v113
    v_lshlrev_b32 v7, 16, v36
    v_sub_f32 v102, v7, v98
    v_sub_f32 v103, v7, v99
    v_cvt_pk_bf16_f32 v104, v102, v103
    v_lshlrev_b32 v102, 16, v104
    v_and_b32 v103, s50, v104
    v_mul_f32 v102, v102, v102
    v_mul_f32 v103, v103, v103
    v_cvt_pk_bf16_f32 v104, v102, v103
    v_lshlrev_b32 v102, 16, v104
    v_and_b32 v103, s50, v104
    v_mul_f32 v102, s51, v102
    v_mul_f32 v103, s51, v103
    v_cvt_pk_bf16_f32 v104, v102, v103
    v_lshlrev_b32 v102, 16, v104
    v_and_b32 v103, s50, v104
    v_mul_f32 v102, s52, v102
    v_mul_f32 v103, s52, v103
    v_exp_f32 v102, v102
    v_exp_f32 v103, v103
    s_nop 0
    v_cvt_pk_bf16_f32 v114, v102, v103
    v_sub_f32 v102, v7, v100
    v_sub_f32 v103, v7, v101
    v_cvt_pk_bf16_f32 v104, v102, v103
    v_lshlrev_b32 v102, 16, v104
    v_and_b32 v103, s50, v104
    v_mul_f32 v102, v102, v102
    v_mul_f32 v103, v103, v103
    v_cvt_pk_bf16_f32 v104, v102, v103
    v_lshlrev_b32 v102, 16, v104
    v_and_b32 v103, s50, v104
    v_mul_f32 v102, s51, v102
    v_mul_f32 v103, s51, v103
    v_cvt_pk_bf16_f32 v104, v102, v103
    v_lshlrev_b32 v102, 16, v104
    v_and_b32 v103, s50, v104
    v_mul_f32 v102, s52, v102
    v_mul_f32 v103, s52, v103
    v_exp_f32 v102, v102
    v_exp_f32 v103, v103
    s_nop 0
    v_cvt_pk_bf16_f32 v115, v102, v103
    s_nop 1
    v_mfma_f32_16x16x16_bf16 v[106:109], v[92:93], v[114:115], 0
    v_mfma_f32_16x16x16_bf16 v[110:113], v[94:95], v[114:115], 0
    s_nop 7
    v_cvt_pk_bf16_f32 v90, v106, v107
    v_cvt_pk_bf16_f32 v91, v108, v109
    v_cvt_pk_bf16_f32 v32, v110, v111
    v_cvt_pk_bf16_f32 v33, v112, v113
    s_add_u32 s53, s3, 0
    s_mul_i32 s54, s53, 4682
    s_lshr_b32 s54, s54, 16
    s_mul_i32 s55, s54, 14
    s_sub_u32 s53, s53, s55
    s_mul_i32 s54, s54, 10976
    s_lshl_b32 s55, s53, 10
    s_add_u32 s54, s54, s55
    s_cmp_ge_u32 s53, 10
    s_cselect_b32 s55, 66592, 0
    s_add_u32 s54, s54, s55
    s_add_u32 s64, s54, 1088
    s_add_u32 s53, s3, 8
    s_mul_i32 s54, s53, 4682
    s_lshr_b32 s54, s54, 16
    s_mul_i32 s55, s54, 14
    s_sub_u32 s53, s53, s55
    s_mul_i32 s54, s54, 10976
    s_lshl_b32 s55, s53, 10
    s_add_u32 s54, s54, s55
    s_cmp_ge_u32 s53, 10
    s_cselect_b32 s55, 66592, 0
    s_add_u32 s54, s54, s55
    s_add_u32 s65, s54, 1088
    s_add_u32 s53, s3, 16
    s_mul_i32 s54, s53, 4682
    s_lshr_b32 s54, s54, 16
    s_mul_i32 s55, s54, 14
    s_sub_u32 s53, s53, s55
    s_mul_i32 s54, s54, 10976
    s_lshl_b32 s55, s53, 10
    s_add_u32 s54, s54, s55
    s_cmp_ge_u32 s53, 10
    s_cselect_b32 s55, 66592, 0
    s_add_u32 s54, s54, s55
    s_add_u32 s66, s54, 1088
    s_add_u32 s53, s3, 24
    s_mul_i32 s54, s53, 4682
    s_lshr_b32 s54, s54, 16
    s_mul_i32 s55, s54, 14
    s_sub_u32 s53, s53, s55
    s_mul_i32 s54, s54, 10976
    s_lshl_b32 s55, s53, 10
    s_add_u32 s54, s54, s55
    s_cmp_ge_u32 s53, 10
    s_cselect_b32 s55, 66592, 0
    s_add_u32 s54, s54, s55
    s_add_u32 s67, s54, 1088
    s_add_u32 s53, s3, 32
    s_mul_i32 s54, s53, 4682
    s_lshr_b32 s54, s54, 16
    s_mul_i32 s55, s54, 14
    s_sub_u32 s53, s53, s55
    s_mul_i32 s54, s54, 10976
    s_lshl_b32 s55, s53, 10
    s_add_u32 s54, s54, s55
    s_cmp_ge_u32 s53, 10
    s_cselect_b32 s55, 66592, 0
    s_add_u32 s54, s54, s55
    s_add_u32 s68, s54, 1088
    s_add_u32 s53, s3, 40
    s_mul_i32 s54, s53, 4682
    s_lshr_b32 s54, s54, 16
    s_mul_i32 s55, s54, 14
    s_sub_u32 s53, s53, s55
    s_mul_i32 s54, s54, 10976
    s_lshl_b32 s55, s53, 10
    s_add_u32 s54, s54, s55
    s_cmp_ge_u32 s53, 10
    s_cselect_b32 s55, 66592, 0
    s_add_u32 s54, s54, s55
    s_add_u32 s69, s54, 1088
    s_add_u32 s53, s3, 48
    s_mul_i32 s54, s53, 4682
    s_lshr_b32 s54, s54, 16
    s_mul_i32 s55, s54, 14
    s_sub_u32 s53, s53, s55
    s_mul_i32 s54, s54, 10976
    s_lshl_b32 s55, s53, 10
    s_add_u32 s54, s54, s55
    s_cmp_ge_u32 s53, 10
    s_cselect_b32 s55, 66592, 0
    s_add_u32 s54, s54, s55
    s_add_u32 s70, s54, 1088
    s_add_u32 s53, s3, 56
    s_mul_i32 s54, s53, 4682
    s_lshr_b32 s54, s54, 16
    s_mul_i32 s55, s54, 14
    s_sub_u32 s53, s53, s55
    s_mul_i32 s54, s54, 10976
    s_lshl_b32 s55, s53, 10
    s_add_u32 s54, s54, s55
    s_cmp_ge_u32 s53, 10
    s_cselect_b32 s55, 66592, 0
    s_add_u32 s54, s54, s55
    s_add_u32 s71, s54, 1088
    s_add_u32 s53, s3, 64
    s_mul_i32 s54, s53, 4682
    s_lshr_b32 s54, s54, 16
    s_mul_i32 s55, s54, 14
    s_sub_u32 s53, s53, s55
    s_mul_i32 s54, s54, 10976
    s_lshl_b32 s55, s53, 10
    s_add_u32 s54, s54, s55
    s_cmp_ge_u32 s53, 10
    s_cselect_b32 s55, 66592, 0
    s_add_u32 s54, s54, s55
    s_add_u32 s72, s54, 1088
    s_add_u32 s53, s3, 72
    s_mul_i32 s54, s53, 4682
    s_lshr_b32 s54, s54, 16
    s_mul_i32 s55, s54, 14
    s_sub_u32 s53, s53, s55
    s_mul_i32 s54, s54, 10976
    s_lshl_b32 s55, s53, 10
    s_add_u32 s54, s54, s55
    s_cmp_ge_u32 s53, 10
    s_cselect_b32 s55, 66592, 0
    s_add_u32 s54, s54, s55
    s_add_u32 s73, s54, 1088
    s_add_u32 s53, s3, 80
    s_mul_i32 s54, s53, 4682
    s_lshr_b32 s54, s54, 16
    s_mul_i32 s55, s54, 14
    s_sub_u32 s53, s53, s55
    s_mul_i32 s54, s54, 10976
    s_lshl_b32 s55, s53, 10
    s_add_u32 s54, s54, s55
    s_cmp_ge_u32 s53, 10
    s_cselect_b32 s55, 66592, 0
    s_add_u32 s54, s54, s55
    s_add_u32 s74, s54, 1088
    s_add_u32 s53, s3, 88
    s_mul_i32 s54, s53, 4682
    s_lshr_b32 s54, s54, 16
    s_mul_i32 s55, s54, 14
    s_sub_u32 s53, s53, s55
    s_mul_i32 s54, s54, 10976
    s_lshl_b32 s55, s53, 10
    s_add_u32 s54, s54, s55
    s_cmp_ge_u32 s53, 10
    s_cselect_b32 s55, 66592, 0
    s_add_u32 s54, s54, s55
    s_add_u32 s75, s54, 1088
    s_add_u32 s53, s3, 96
    s_mul_i32 s54, s53, 4682
    s_lshr_b32 s54, s54, 16
    s_mul_i32 s55, s54, 14
    s_sub_u32 s53, s53, s55
    s_mul_i32 s54, s54, 10976
    s_lshl_b32 s55, s53, 10
    s_add_u32 s54, s54, s55
    s_cmp_ge_u32 s53, 10
    s_cselect_b32 s55, 66592, 0
    s_add_u32 s54, s54, s55
    s_add_u32 s76, s54, 1088
    v_mov_b32 v38, 0xffff0000
    v_mov_b32 v37, 1024
    s_waitcnt vmcnt(0)
    s_barrier
    ds_read_b32 v39, v37
    v_add_u32 v7, s64, v5
    ds_read_b128 v[102:105], v7
    v_add_u32 v7, s65, v5
    ds_read_b128 v[106:109], v7
    s_waitcnt lgkmcnt(2)
    v_readfirstlane_b32 s63, v39
    s_cmp_eq_u32 s63, 0
    s_cbranch_scc1 K2_fast
    s_waitcnt lgkmcnt(0)
    s_mov_b32 s28, s20
    s_mov_b32 s29, s21
    s_mov_b32 s30, 512
    s_mov_b32 s31, 0x20000
    buffer_load_ushort v104, v6, s[28:31], 0 offen offset:0
    buffer_load_ushort v105, v6, s[28:31], 0 offen offset:32
    buffer_load_ushort v106, v6, s[28:31], 0 offen offset:64
    buffer_load_ushort v107, v6, s[28:31], 0 offen offset:96
    s_mov_b32 s32, s6
    s_mov_b32 s33, s7
    s_mov_b32 s34, 38404096
    s_mov_b32 s35, 0x20000
    s_and_b32 s36, s2, 7
    s_lshl_b32 s36, s36, 5
    s_lshr_b32 s37, s2, 3
    s_add_u32 s36, s36, s37
    s_lshl_b32 s36, s36, 5
    s_add_u32 s36, s36, 41943040
    s_add_u32 s36, s6, s36
    s_addc_u32 s37, s7, 0
    s_mov_b32 s38, 2088992
    s_mov_b32 s39, 0x20000
    s_mov_b32 s60, 0xffff
    s_waitcnt vmcnt(0)
    v_lshl_or_b32 v102, v105, 16, v104
    v_lshl_or_b32 v103, v107, 16, v106
    s_mov_b32 s53, 0
K2_sq:
    s_lshl_b32 s64, s3, 10
    v_add_u32 v7, s64, v5
    v_add_u32 v7, 154752, v7
    v_mov_b32 v118, 0
    v_mov_b32 v119, 0
    v_mov_b32 v120, 0
    v_mov_b32 v121, 0
    ds_write_b128 v7, v[118:121] offset:0
    s_waitcnt lgkmcnt(0)
    s_barrier
    s_mov_b32 s54, s3
K2_sw:
    s_mul_i32 s58, s54, 150016
    s_mov_b32 s55, 0
K2_sr:
    s_lshl_b32 s64, s54, 13
    s_lshl_b32 s65, s55, 2
    s_add_u32 s64, s64, s65
    buffer_load_dword v108, off, s[36:39], s64
    s_mul_i32 s59, s55, 80000
    s_waitcnt vmcnt(0)
    v_readfirstlane_b32 s66, v108
    s_nop 3
    s_and_b32 s56, s66, 0xffff
    s_lshr_b32 s57, s66, 16
    s_add_u32 s57, s57, s56
K2_sp:
    s_cmp_ge_u32 s56, s57
    s_cbranch_scc1 K2_sp_done
    v_add_u32 v116, s56, v1
    v_cmp_gt_u32 vcc, s57, v116
    s_and_saveexec_b64 s[62:63], vcc
    v_mul_u32_u24 v110, 6, v116
    v_and_b32 v111, 1, v116
    v_lshl_add_u32 v117, v111, 1, v110
    v_mad_i32_i24 v111, v111, -4, v110
    buffer_load_dword v108, v117, s[32:35], s58 offen
    buffer_load_ushort v109, v111, s[32:35], s58 offen offset:4
    s_mul_i32 s64, s53, 64
    s_waitcnt vmcnt(0)
    v_lshrrev_b32 v115, 15, v109
    v_and_b32 v109, 0x7ff, v109
    v_subrev_u32 v109, s64, v109
    s_movk_i32 s65, 64
    v_cmp_gt_u32 vcc, s65, v109
    s_and_b64 exec, exec, vcc
    s_cbranch_execz K2_sp_next
    v_and_b32 v110, s60, v108
    v_lshl_or_b32 v110, v115, 16, v110
    v_add_u32 v110, s59, v110
    v_lshlrev_b32 v110, 5, v110
    buffer_load_dwordx4 v[118:121], v110, s[24:27], 0 offen
    buffer_load_dwordx4 v[122:125], v110, s[24:27], 0 offen offset:16
    v_and_b32 v112, s50, v108
    v_lshlrev_b32 v113, 7, v109
    v_add_u32 v113, 154752, v113
    s_waitcnt vmcnt(0)
    v_lshlrev_b32 v114, 16, v118
    v_mul_f32 v114, v114, v112
    v_cvt_f64_f32 v[126:127], v114
    ds_add_f64 v113, v[126:127] offset:0
    v_and_b32 v114, s50, v118
    v_mul_f32 v114, v114, v112
    v_cvt_f64_f32 v[126:127], v114
    ds_add_f64 v113, v[126:127] offset:8
    v_lshlrev_b32 v114, 16, v119
    v_mul_f32 v114, v114, v112
    v_cvt_f64_f32 v[126:127], v114
    ds_add_f64 v113, v[126:127] offset:16
    v_and_b32 v114, s50, v119
    v_mul_f32 v114, v114, v112
    v_cvt_f64_f32 v[126:127], v114
    ds_add_f64 v113, v[126:127] offset:24
    v_lshlrev_b32 v114, 16, v120
    v_mul_f32 v114, v114, v112
    v_cvt_f64_f32 v[126:127], v114
    ds_add_f64 v113, v[126:127] offset:32
    v_and_b32 v114, s50, v120
    v_mul_f32 v114, v114, v112
    v_cvt_f64_f32 v[126:127], v114
    ds_add_f64 v113, v[126:127] offset:40
    v_lshlrev_b32 v114, 16, v121
    v_mul_f32 v114, v114, v112
    v_cvt_f64_f32 v[126:127], v114
    ds_add_f64 v113, v[126:127] offset:48
    v_and_b32 v114, s50, v121
    v_mul_f32 v114, v114, v112
    v_cvt_f64_f32 v[126:127], v114
    ds_add_f64 v113, v[126:127] offset:56
    v_lshlrev_b32 v114, 16, v122
    v_mul_f32 v114, v114, v112
    v_cvt_f64_f32 v[126:127], v114
    ds_add_f64 v113, v[126:127] offset:64
    v_and_b32 v114, s50, v122
    v_mul_f32 v114, v114, v112
    v_cvt_f64_f32 v[126:127], v114
    ds_add_f64 v113, v[126:127] offset:72
    v_lshlrev_b32 v114, 16, v123
    v_mul_f32 v114, v114, v112
    v_cvt_f64_f32 v[126:127], v114
    ds_add_f64 v113, v[126:127] offset:80
    v_and_b32 v114, s50, v123
    v_mul_f32 v114, v114, v112
    v_cvt_f64_f32 v[126:127], v114
    ds_add_f64 v113, v[126:127] offset:88
    v_lshlrev_b32 v114, 16, v124
    v_mul_f32 v114, v114, v112
    v_cvt_f64_f32 v[126:127], v114
    ds_add_f64 v113, v[126:127] offset:96
    v_and_b32 v114, s50, v124
    v_mul_f32 v114, v114, v112
    v_cvt_f64_f32 v[126:127], v114
    ds_add_f64 v113, v[126:127] offset:104
    v_lshlrev_b32 v114, 16, v125
    v_mul_f32 v114, v114, v112
    v_cvt_f64_f32 v[126:127], v114
    ds_add_f64 v113, v[126:127] offset:112
    v_and_b32 v114, s50, v125
    v_mul_f32 v114, v114, v112
    v_cvt_f64_f32 v[126:127], v114
    ds_add_f64 v113, v[126:127] offset:120
K2_sp_next:
    s_mov_b64 exec, s[62:63]
    s_add_u32 s56, s56, 64
    s_branch K2_sp
K2_sp_done:
    s_add_u32 s55, s55, 1
    s_cmp_lt_u32 s55, 5
    s_cbranch_scc1 K2_sr
    s_add_u32 s54, s54, 8
    s_cmp_lt_u32 s54, 256
    s_cbranch_scc1 K2_sw
    s_waitcnt lgkmcnt(0)
    s_barrier
    s_mov_b32 s54, s3
    s_cmp_ge_u32 s54, 4
    s_cbranch_scc1 K2_sc_done
K2_sc:
    s_mul_i32 s64, s53, 4
    s_add_u32 s64, s64, s54
    s_cmp_ge_u32 s64, 98
    s_cbranch_scc1 K2_sc_done
    s_lshl_b32 s65, s54, 11
    v_lshlrev_b32 v7, 7, v2
    v_lshl_add_u32 v7, v3, 5, v7
    v_add_u32 v7, s65, v7
    v_add_u32 v7, 154752, v7
    ds_read_b128 v[118:121], v7
    ds_read_b128 v[122:125], v7 offset:16
    s_mul_i32 s65, s64, 4682
    s_lshr_b32 s65, s65, 16
    s_mul_i32 s66, s65, 14
    s_sub_u32 s64, s64, s66
    s_mul_i32 s65, s65, 10976
    s_lshl_b32 s66, s64, 10
    s_add_u32 s65, s65, s66
    s_cmp_ge_u32 s64, 10
    s_cselect_b32 s66, 66592, 0
    s_add_u32 s65, s65, s66
    s_add_u32 s65, s65, 1088
    s_waitcnt lgkmcnt(0)
    v_cvt_f32_f64 v108, v[118:119]
    v_cvt_f32_f64 v109, v[120:121]
    v_cvt_f32_f64 v110, v[122:123]
    v_cvt_f32_f64 v111, v[124:125]
    s_nop 0
    v_cvt_pk_bf16_f32 v112, v108, v109
    v_cvt_pk_bf16_f32 v113, v110, v111
    v_add_u32 v7, s65, v5
    s_nop 1
    v_mfma_f32_16x16x16_bf16 v[118:121], v[102:103], v[112:113], 0
    s_nop 7
    s_nop 1
    ds_write_b128 v7, v[118:121]
    s_add_u32 s54, s54, 8
    s_cmp_lt_u32 s54, 4
    s_cbranch_scc1 K2_sc
K2_sc_done:
    s_waitcnt lgkmcnt(0)
    s_barrier
    s_add_u32 s53, s53, 1
    s_cmp_lt_u32 s53, 25
    s_cbranch_scc1 K2_sq
    s_add_u32 s53, s3, 0
    s_mul_i32 s54, s53, 4682
    s_lshr_b32 s54, s54, 16
    s_mul_i32 s55, s54, 14
    s_sub_u32 s53, s53, s55
    s_mul_i32 s54, s54, 10976
    s_lshl_b32 s55, s53, 10
    s_add_u32 s54, s54, s55
    s_cmp_ge_u32 s53, 10
    s_cselect_b32 s55, 66592, 0
    s_add_u32 s54, s54, s55
    s_add_u32 s64, s54, 1088
    s_add_u32 s53, s3, 8
    s_mul_i32 s54, s53, 4682
    s_lshr_b32 s54, s54, 16
    s_mul_i32 s55, s54, 14
    s_sub_u32 s53, s53, s55
    s_mul_i32 s54, s54, 10976
    s_lshl_b32 s55, s53, 10
    s_add_u32 s54, s54, s55
    s_cmp_ge_u32 s53, 10
    s_cselect_b32 s55, 66592, 0
    s_add_u32 s54, s54, s55
    s_add_u32 s65, s54, 1088
    s_add_u32 s53, s3, 16
    s_mul_i32 s54, s53, 4682
    s_lshr_b32 s54, s54, 16
    s_mul_i32 s55, s54, 14
    s_sub_u32 s53, s53, s55
    s_mul_i32 s54, s54, 10976
    s_lshl_b32 s55, s53, 10
    s_add_u32 s54, s54, s55
    s_cmp_ge_u32 s53, 10
    s_cselect_b32 s55, 66592, 0
    s_add_u32 s54, s54, s55
    s_add_u32 s66, s54, 1088
    s_add_u32 s53, s3, 24
    s_mul_i32 s54, s53, 4682
    s_lshr_b32 s54, s54, 16
    s_mul_i32 s55, s54, 14
    s_sub_u32 s53, s53, s55
    s_mul_i32 s54, s54, 10976
    s_lshl_b32 s55, s53, 10
    s_add_u32 s54, s54, s55
    s_cmp_ge_u32 s53, 10
    s_cselect_b32 s55, 66592, 0
    s_add_u32 s54, s54, s55
    s_add_u32 s67, s54, 1088
    s_add_u32 s53, s3, 32
    s_mul_i32 s54, s53, 4682
    s_lshr_b32 s54, s54, 16
    s_mul_i32 s55, s54, 14
    s_sub_u32 s53, s53, s55
    s_mul_i32 s54, s54, 10976
    s_lshl_b32 s55, s53, 10
    s_add_u32 s54, s54, s55
    s_cmp_ge_u32 s53, 10
    s_cselect_b32 s55, 66592, 0
    s_add_u32 s54, s54, s55
    s_add_u32 s68, s54, 1088
    s_add_u32 s53, s3, 40
    s_mul_i32 s54, s53, 4682
    s_lshr_b32 s54, s54, 16
    s_mul_i32 s55, s54, 14
    s_sub_u32 s53, s53, s55
    s_mul_i32 s54, s54, 10976
    s_lshl_b32 s55, s53, 10
    s_add_u32 s54, s54, s55
    s_cmp_ge_u32 s53, 10
    s_cselect_b32 s55, 66592, 0
    s_add_u32 s54, s54, s55
    s_add_u32 s69, s54, 1088
    s_add_u32 s53, s3, 48
    s_mul_i32 s54, s53, 4682
    s_lshr_b32 s54, s54, 16
    s_mul_i32 s55, s54, 14
    s_sub_u32 s53, s53, s55
    s_mul_i32 s54, s54, 10976
    s_lshl_b32 s55, s53, 10
    s_add_u32 s54, s54, s55
    s_cmp_ge_u32 s53, 10
    s_cselect_b32 s55, 66592, 0
    s_add_u32 s54, s54, s55
    s_add_u32 s70, s54, 1088
    s_add_u32 s53, s3, 56
    s_mul_i32 s54, s53, 4682
    s_lshr_b32 s54, s54, 16
    s_mul_i32 s55, s54, 14
    s_sub_u32 s53, s53, s55
    s_mul_i32 s54, s54, 10976
    s_lshl_b32 s55, s53, 10
    s_add_u32 s54, s54, s55
    s_cmp_ge_u32 s53, 10
    s_cselect_b32 s55, 66592, 0
    s_add_u32 s54, s54, s55
    s_add_u32 s71, s54, 1088
    s_add_u32 s53, s3, 64
    s_mul_i32 s54, s53, 4682
    s_lshr_b32 s54, s54, 16
    s_mul_i32 s55, s54, 14
    s_sub_u32 s53, s53, s55
    s_mul_i32 s54, s54, 10976
    s_lshl_b32 s55, s53, 10
    s_add_u32 s54, s54, s55
    s_cmp_ge_u32 s53, 10
    s_cselect_b32 s55, 66592, 0
    s_add_u32 s54, s54, s55
    s_add_u32 s72, s54, 1088
    s_add_u32 s53, s3, 72
    s_mul_i32 s54, s53, 4682
    s_lshr_b32 s54, s54, 16
    s_mul_i32 s55, s54, 14
    s_sub_u32 s53, s53, s55
    s_mul_i32 s54, s54, 10976
    s_lshl_b32 s55, s53, 10
    s_add_u32 s54, s54, s55
    s_cmp_ge_u32 s53, 10
    s_cselect_b32 s55, 66592, 0
    s_add_u32 s54, s54, s55
    s_add_u32 s73, s54, 1088
    s_add_u32 s53, s3, 80
    s_mul_i32 s54, s53, 4682
    s_lshr_b32 s54, s54, 16
    s_mul_i32 s55, s54, 14
    s_sub_u32 s53, s53, s55
    s_mul_i32 s54, s54, 10976
    s_lshl_b32 s55, s53, 10
    s_add_u32 s54, s54, s55
    s_cmp_ge_u32 s53, 10
    s_cselect_b32 s55, 66592, 0
    s_add_u32 s54, s54, s55
    s_add_u32 s74, s54, 1088
    s_add_u32 s53, s3, 88
    s_mul_i32 s54, s53, 4682
    s_lshr_b32 s54, s54, 16
    s_mul_i32 s55, s54, 14
    s_sub_u32 s53, s53, s55
    s_mul_i32 s54, s54, 10976
    s_lshl_b32 s55, s53, 10
    s_add_u32 s54, s54, s55
    s_cmp_ge_u32 s53, 10
    s_cselect_b32 s55, 66592, 0
    s_add_u32 s54, s54, s55
    s_add_u32 s75, s54, 1088
    s_add_u32 s53, s3, 96
    s_mul_i32 s54, s53, 4682
    s_lshr_b32 s54, s54, 16
    s_mul_i32 s55, s54, 14
    s_sub_u32 s53, s53, s55
    s_mul_i32 s54, s54, 10976
    s_lshl_b32 s55, s53, 10
    s_add_u32 s54, s54, s55
    s_cmp_ge_u32 s53, 10
    s_cselect_b32 s55, 66592, 0
    s_add_u32 s54, s54, s55
    s_add_u32 s76, s54, 1088
    v_add_u32 v7, s64, v5
    ds_read_b128 v[102:105], v7
    v_add_u32 v7, s65, v5
    ds_read_b128 v[106:109], v7
K2_fast:
    v_lshlrev_b32 v114, 16, v66
    v_and_b32 v115, v38, v66
    v_lshlrev_b32 v116, 16, v67
    v_and_b32 v117, v38, v67
    s_waitcnt lgkmcnt(1)
    v_mul_f32 v114, v114, v102
    v_mul_f32 v115, v115, v103
    v_mul_f32 v116, v116, v104
    v_mul_f32 v117, v117, v105
    v_cvt_pk_bf16_f32 v102, v114, v115
    v_cvt_pk_bf16_f32 v103, v116, v117
    v_add_u32 v7, s66, v5
    ds_read_b128 v[110:113], v7
    v_mfma_f32_16x16x16_bf16 v[118:121], v[96:97], v[102:103], 0
    v_lshlrev_b32 v114, 16, v8
    v_and_b32 v115, v38, v8
    v_lshlrev_b32 v116, 16, v9
    v_and_b32 v117, v38, v9
    v_lshlrev_b32 v122, 16, v40
    v_and_b32 v123, v38, v40
    v_lshlrev_b32 v124, 16, v41
    v_and_b32 v125, v38, v41
    v_fma_f32 v122, v118, v114, v122
    v_fma_f32 v123, v119, v115, v123
    v_fma_f32 v124, v120, v116, v124
    v_fma_f32 v125, v121, v117, v125
    v_cvt_pk_bf16_f32 v40, v122, v123
    v_cvt_pk_bf16_f32 v41, v124, v125
    s_mov_b32 s48, 0
    buffer_store_dwordx2 v[40:41], v4, s[44:47], s48 offen sc0 sc1
    v_lshlrev_b32 v114, 16, v68
    v_and_b32 v115, v38, v68
    v_lshlrev_b32 v116, 16, v69
    v_and_b32 v117, v38, v69
    s_waitcnt lgkmcnt(1)
    v_mul_f32 v114, v114, v106
    v_mul_f32 v115, v115, v107
    v_mul_f32 v116, v116, v108
    v_mul_f32 v117, v117, v109
    v_cvt_pk_bf16_f32 v106, v114, v115
    v_cvt_pk_bf16_f32 v107, v116, v117
    v_add_u32 v7, s67, v5
    ds_read_b128 v[102:105], v7
    v_mfma_f32_16x16x16_bf16 v[118:121], v[96:97], v[106:107], 0
    v_lshlrev_b32 v114, 16, v10
    v_and_b32 v115, v38, v10
    v_lshlrev_b32 v116, 16, v11
    v_and_b32 v117, v38, v11
    v_lshlrev_b32 v122, 16, v42
    v_and_b32 v123, v38, v42
    v_lshlrev_b32 v124, 16, v43
    v_and_b32 v125, v38, v43
    v_fma_f32 v122, v118, v114, v122
    v_fma_f32 v123, v119, v115, v123
    v_fma_f32 v124, v120, v116, v124
    v_fma_f32 v125, v121, v117, v125
    v_cvt_pk_bf16_f32 v42, v122, v123
    v_cvt_pk_bf16_f32 v43, v124, v125
    s_mov_b32 s48, 1048576
    buffer_store_dwordx2 v[42:43], v4, s[44:47], s48 offen sc0 sc1
    v_lshlrev_b32 v114, 16, v70
    v_and_b32 v115, v38, v70
    v_lshlrev_b32 v116, 16, v71
    v_and_b32 v117, v38, v71
    s_waitcnt lgkmcnt(1)
    v_mul_f32 v114, v114, v110
    v_mul_f32 v115, v115, v111
    v_mul_f32 v116, v116, v112
    v_mul_f32 v117, v117, v113
    v_cvt_pk_bf16_f32 v110, v114, v115
    v_cvt_pk_bf16_f32 v111, v116, v117
    v_add_u32 v7, s68, v5
    ds_read_b128 v[106:109], v7
    v_mfma_f32_16x16x16_bf16 v[118:121], v[96:97], v[110:111], 0
    v_lshlrev_b32 v114, 16, v12
    v_and_b32 v115, v38, v12
    v_lshlrev_b32 v116, 16, v13
    v_and_b32 v117, v38, v13
    v_lshlrev_b32 v122, 16, v44
    v_and_b32 v123, v38, v44
    v_lshlrev_b32 v124, 16, v45
    v_and_b32 v125, v38, v45
    v_fma_f32 v122, v118, v114, v122
    v_fma_f32 v123, v119, v115, v123
    v_fma_f32 v124, v120, v116, v124
    v_fma_f32 v125, v121, v117, v125
    v_cvt_pk_bf16_f32 v44, v122, v123
    v_cvt_pk_bf16_f32 v45, v124, v125
    s_mov_b32 s48, 2097152
    buffer_store_dwordx2 v[44:45], v4, s[44:47], s48 offen sc0 sc1
    v_lshlrev_b32 v114, 16, v72
    v_and_b32 v115, v38, v72
    v_lshlrev_b32 v116, 16, v73
    v_and_b32 v117, v38, v73
    s_waitcnt lgkmcnt(1)
    v_mul_f32 v114, v114, v102
    v_mul_f32 v115, v115, v103
    v_mul_f32 v116, v116, v104
    v_mul_f32 v117, v117, v105
    v_cvt_pk_bf16_f32 v102, v114, v115
    v_cvt_pk_bf16_f32 v103, v116, v117
    v_add_u32 v7, s69, v5
    ds_read_b128 v[110:113], v7
    v_mfma_f32_16x16x16_bf16 v[118:121], v[96:97], v[102:103], 0
    v_lshlrev_b32 v114, 16, v14
    v_and_b32 v115, v38, v14
    v_lshlrev_b32 v116, 16, v15
    v_and_b32 v117, v38, v15
    v_lshlrev_b32 v122, 16, v46
    v_and_b32 v123, v38, v46
    v_lshlrev_b32 v124, 16, v47
    v_and_b32 v125, v38, v47
    v_fma_f32 v122, v118, v114, v122
    v_fma_f32 v123, v119, v115, v123
    v_fma_f32 v124, v120, v116, v124
    v_fma_f32 v125, v121, v117, v125
    v_cvt_pk_bf16_f32 v46, v122, v123
    v_cvt_pk_bf16_f32 v47, v124, v125
    s_mov_b32 s48, 3145728
    buffer_store_dwordx2 v[46:47], v4, s[44:47], s48 offen sc0 sc1
    v_lshlrev_b32 v114, 16, v74
    v_and_b32 v115, v38, v74
    v_lshlrev_b32 v116, 16, v75
    v_and_b32 v117, v38, v75
    s_waitcnt lgkmcnt(1)
    v_mul_f32 v114, v114, v106
    v_mul_f32 v115, v115, v107
    v_mul_f32 v116, v116, v108
    v_mul_f32 v117, v117, v109
    v_cvt_pk_bf16_f32 v106, v114, v115
    v_cvt_pk_bf16_f32 v107, v116, v117
    v_add_u32 v7, s70, v5
    ds_read_b128 v[102:105], v7
    v_mfma_f32_16x16x16_bf16 v[118:121], v[96:97], v[106:107], 0
    v_lshlrev_b32 v114, 16, v16
    v_and_b32 v115, v38, v16
    v_lshlrev_b32 v116, 16, v17
    v_and_b32 v117, v38, v17
    v_lshlrev_b32 v122, 16, v48
    v_and_b32 v123, v38, v48
    v_lshlrev_b32 v124, 16, v49
    v_and_b32 v125, v38, v49
    v_fma_f32 v122, v118, v114, v122
    v_fma_f32 v123, v119, v115, v123
    v_fma_f32 v124, v120, v116, v124
    v_fma_f32 v125, v121, v117, v125
    v_cvt_pk_bf16_f32 v48, v122, v123
    v_cvt_pk_bf16_f32 v49, v124, v125
    s_mov_b32 s48, 4194304
    buffer_store_dwordx2 v[48:49], v4, s[44:47], s48 offen sc0 sc1
    v_lshlrev_b32 v114, 16, v76
    v_and_b32 v115, v38, v76
    v_lshlrev_b32 v116, 16, v77
    v_and_b32 v117, v38, v77
    s_waitcnt lgkmcnt(1)
    v_mul_f32 v114, v114, v110
    v_mul_f32 v115, v115, v111
    v_mul_f32 v116, v116, v112
    v_mul_f32 v117, v117, v113
    v_cvt_pk_bf16_f32 v110, v114, v115
    v_cvt_pk_bf16_f32 v111, v116, v117
    v_add_u32 v7, s71, v5
    ds_read_b128 v[106:109], v7
    v_mfma_f32_16x16x16_bf16 v[118:121], v[96:97], v[110:111], 0
    v_lshlrev_b32 v114, 16, v18
    v_and_b32 v115, v38, v18
    v_lshlrev_b32 v116, 16, v19
    v_and_b32 v117, v38, v19
    v_lshlrev_b32 v122, 16, v50
    v_and_b32 v123, v38, v50
    v_lshlrev_b32 v124, 16, v51
    v_and_b32 v125, v38, v51
    v_fma_f32 v122, v118, v114, v122
    v_fma_f32 v123, v119, v115, v123
    v_fma_f32 v124, v120, v116, v124
    v_fma_f32 v125, v121, v117, v125
    v_cvt_pk_bf16_f32 v50, v122, v123
    v_cvt_pk_bf16_f32 v51, v124, v125
    s_mov_b32 s48, 5242880
    buffer_store_dwordx2 v[50:51], v4, s[44:47], s48 offen sc0 sc1
    v_lshlrev_b32 v114, 16, v78
    v_and_b32 v115, v38, v78
    v_lshlrev_b32 v116, 16, v79
    v_and_b32 v117, v38, v79
    s_waitcnt lgkmcnt(1)
    v_mul_f32 v114, v114, v102
    v_mul_f32 v115, v115, v103
    v_mul_f32 v116, v116, v104
    v_mul_f32 v117, v117, v105
    v_cvt_pk_bf16_f32 v102, v114, v115
    v_cvt_pk_bf16_f32 v103, v116, v117
    v_add_u32 v7, s72, v5
    ds_read_b128 v[110:113], v7
    v_mfma_f32_16x16x16_bf16 v[118:121], v[96:97], v[102:103], 0
    v_lshlrev_b32 v114, 16, v20
    v_and_b32 v115, v38, v20
    v_lshlrev_b32 v116, 16, v21
    v_and_b32 v117, v38, v21
    v_lshlrev_b32 v122, 16, v52
    v_and_b32 v123, v38, v52
    v_lshlrev_b32 v124, 16, v53
    v_and_b32 v125, v38, v53
    v_fma_f32 v122, v118, v114, v122
    v_fma_f32 v123, v119, v115, v123
    v_fma_f32 v124, v120, v116, v124
    v_fma_f32 v125, v121, v117, v125
    v_cvt_pk_bf16_f32 v52, v122, v123
    v_cvt_pk_bf16_f32 v53, v124, v125
    s_mov_b32 s48, 6291456
    buffer_store_dwordx2 v[52:53], v4, s[44:47], s48 offen sc0 sc1
    v_lshlrev_b32 v114, 16, v80
    v_and_b32 v115, v38, v80
    v_lshlrev_b32 v116, 16, v81
    v_and_b32 v117, v38, v81
    s_waitcnt lgkmcnt(1)
    v_mul_f32 v114, v114, v106
    v_mul_f32 v115, v115, v107
    v_mul_f32 v116, v116, v108
    v_mul_f32 v117, v117, v109
    v_cvt_pk_bf16_f32 v106, v114, v115
    v_cvt_pk_bf16_f32 v107, v116, v117
    v_add_u32 v7, s73, v5
    ds_read_b128 v[102:105], v7
    v_mfma_f32_16x16x16_bf16 v[118:121], v[96:97], v[106:107], 0
    v_lshlrev_b32 v114, 16, v22
    v_and_b32 v115, v38, v22
    v_lshlrev_b32 v116, 16, v23
    v_and_b32 v117, v38, v23
    v_lshlrev_b32 v122, 16, v54
    v_and_b32 v123, v38, v54
    v_lshlrev_b32 v124, 16, v55
    v_and_b32 v125, v38, v55
    v_fma_f32 v122, v118, v114, v122
    v_fma_f32 v123, v119, v115, v123
    v_fma_f32 v124, v120, v116, v124
    v_fma_f32 v125, v121, v117, v125
    v_cvt_pk_bf16_f32 v54, v122, v123
    v_cvt_pk_bf16_f32 v55, v124, v125
    s_mov_b32 s48, 7340032
    buffer_store_dwordx2 v[54:55], v4, s[44:47], s48 offen sc0 sc1
    v_lshlrev_b32 v114, 16, v82
    v_and_b32 v115, v38, v82
    v_lshlrev_b32 v116, 16, v83
    v_and_b32 v117, v38, v83
    s_waitcnt lgkmcnt(1)
    v_mul_f32 v114, v114, v110
    v_mul_f32 v115, v115, v111
    v_mul_f32 v116, v116, v112
    v_mul_f32 v117, v117, v113
    v_cvt_pk_bf16_f32 v110, v114, v115
    v_cvt_pk_bf16_f32 v111, v116, v117
    v_add_u32 v7, s74, v5
    ds_read_b128 v[106:109], v7
    v_mfma_f32_16x16x16_bf16 v[118:121], v[96:97], v[110:111], 0
    v_lshlrev_b32 v114, 16, v24
    v_and_b32 v115, v38, v24
    v_lshlrev_b32 v116, 16, v25
    v_and_b32 v117, v38, v25
    v_lshlrev_b32 v122, 16, v56
    v_and_b32 v123, v38, v56
    v_lshlrev_b32 v124, 16, v57
    v_and_b32 v125, v38, v57
    v_fma_f32 v122, v118, v114, v122
    v_fma_f32 v123, v119, v115, v123
    v_fma_f32 v124, v120, v116, v124
    v_fma_f32 v125, v121, v117, v125
    v_cvt_pk_bf16_f32 v56, v122, v123
    v_cvt_pk_bf16_f32 v57, v124, v125
    s_mov_b32 s48, 8388608
    buffer_store_dwordx2 v[56:57], v4, s[44:47], s48 offen sc0 sc1
    v_lshlrev_b32 v114, 16, v84
    v_and_b32 v115, v38, v84
    v_lshlrev_b32 v116, 16, v85
    v_and_b32 v117, v38, v85
    s_waitcnt lgkmcnt(1)
    v_mul_f32 v114, v114, v102
    v_mul_f32 v115, v115, v103
    v_mul_f32 v116, v116, v104
    v_mul_f32 v117, v117, v105
    v_cvt_pk_bf16_f32 v102, v114, v115
    v_cvt_pk_bf16_f32 v103, v116, v117
    v_add_u32 v7, s75, v5
    ds_read_b128 v[110:113], v7
    v_mfma_f32_16x16x16_bf16 v[118:121], v[96:97], v[102:103], 0
    v_lshlrev_b32 v114, 16, v26
    v_and_b32 v115, v38, v26
    v_lshlrev_b32 v116, 16, v27
    v_and_b32 v117, v38, v27
    v_lshlrev_b32 v122, 16, v58
    v_and_b32 v123, v38, v58
    v_lshlrev_b32 v124, 16, v59
    v_and_b32 v125, v38, v59
    v_fma_f32 v122, v118, v114, v122
    v_fma_f32 v123, v119, v115, v123
    v_fma_f32 v124, v120, v116, v124
    v_fma_f32 v125, v121, v117, v125
    v_cvt_pk_bf16_f32 v58, v122, v123
    v_cvt_pk_bf16_f32 v59, v124, v125
    s_mov_b32 s48, 9437184
    buffer_store_dwordx2 v[58:59], v4, s[44:47], s48 offen sc0 sc1
    v_lshlrev_b32 v114, 16, v86
    v_and_b32 v115, v38, v86
    v_lshlrev_b32 v116, 16, v87
    v_and_b32 v117, v38, v87
    s_waitcnt lgkmcnt(1)
    v_mul_f32 v114, v114, v106
    v_mul_f32 v115, v115, v107
    v_mul_f32 v116, v116, v108
    v_mul_f32 v117, v117, v109
    v_cvt_pk_bf16_f32 v106, v114, v115
    v_cvt_pk_bf16_f32 v107, v116, v117
    v_add_u32 v7, s76, v5
    ds_read_b128 v[102:105], v7
    v_mfma_f32_16x16x16_bf16 v[118:121], v[96:97], v[106:107], 0
    v_lshlrev_b32 v114, 16, v28
    v_and_b32 v115, v38, v28
    v_lshlrev_b32 v116, 16, v29
    v_and_b32 v117, v38, v29
    v_lshlrev_b32 v122, 16, v60
    v_and_b32 v123, v38, v60
    v_lshlrev_b32 v124, 16, v61
    v_and_b32 v125, v38, v61
    v_fma_f32 v122, v118, v114, v122
    v_fma_f32 v123, v119, v115, v123
    v_fma_f32 v124, v120, v116, v124
    v_fma_f32 v125, v121, v117, v125
    v_cvt_pk_bf16_f32 v60, v122, v123
    v_cvt_pk_bf16_f32 v61, v124, v125
    s_mov_b32 s48, 10485760
    buffer_store_dwordx2 v[60:61], v4, s[44:47], s48 offen sc0 sc1
    v_lshlrev_b32 v114, 16, v88
    v_and_b32 v115, v38, v88
    v_lshlrev_b32 v116, 16, v89
    v_and_b32 v117, v38, v89
    s_waitcnt lgkmcnt(1)
    v_mul_f32 v114, v114, v110
    v_mul_f32 v115, v115, v111
    v_mul_f32 v116, v116, v112
    v_mul_f32 v117, v117, v113
    v_cvt_pk_bf16_f32 v110, v114, v115
    v_cvt_pk_bf16_f32 v111, v116, v117
    s_nop 1
    v_mfma_f32_16x16x16_bf16 v[118:121], v[96:97], v[110:111], 0
    v_lshlrev_b32 v114, 16, v30
    v_and_b32 v115, v38, v30
    v_lshlrev_b32 v116, 16, v31
    v_and_b32 v117, v38, v31
    v_lshlrev_b32 v122, 16, v62
    v_and_b32 v123, v38, v62
    v_lshlrev_b32 v124, 16, v63
    v_and_b32 v125, v38, v63
    v_fma_f32 v122, v118, v114, v122
    v_fma_f32 v123, v119, v115, v123
    v_fma_f32 v124, v120, v116, v124
    v_fma_f32 v125, v121, v117, v125
    v_cvt_pk_bf16_f32 v62, v122, v123
    v_cvt_pk_bf16_f32 v63, v124, v125
    s_mov_b32 s48, 11534336
    buffer_store_dwordx2 v[62:63], v4, s[44:47], s48 offen sc0 sc1
    v_lshlrev_b32 v114, 16, v90
    v_and_b32 v115, v38, v90
    v_lshlrev_b32 v116, 16, v91
    v_and_b32 v117, v38, v91
    s_waitcnt lgkmcnt(0)
    v_mul_f32 v114, v114, v102
    v_mul_f32 v115, v115, v103
    v_mul_f32 v116, v116, v104
    v_mul_f32 v117, v117, v105
    v_cvt_pk_bf16_f32 v102, v114, v115
    v_cvt_pk_bf16_f32 v103, v116, v117
    s_nop 1
    v_mfma_f32_16x16x16_bf16 v[118:121], v[96:97], v[102:103], 0
    v_lshlrev_b32 v114, 16, v32
    v_and_b32 v115, v38, v32
    v_lshlrev_b32 v116, 16, v33
    v_and_b32 v117, v38, v33
    v_lshlrev_b32 v122, 16, v64
    v_and_b32 v123, v38, v64
    v_lshlrev_b32 v124, 16, v65
    v_and_b32 v125, v38, v65
    v_fma_f32 v122, v118, v114, v122
    v_fma_f32 v123, v119, v115, v123
    v_fma_f32 v124, v120, v116, v124
    v_fma_f32 v125, v121, v117, v125
    v_cvt_pk_bf16_f32 v64, v122, v123
    v_cvt_pk_bf16_f32 v65, v124, v125
    s_mov_b32 s48, 12582912
    buffer_store_dwordx2 v[64:65], v4, s[44:47], s48 offen sc0 sc1
K2_end:
    s_endpgm
.section .rodata,"a"
.p2align 6
.amdhsa_kernel gem_part_kernel
  .amdhsa_next_free_vgpr 104
  .amdhsa_next_free_sgpr 80
  .amdhsa_accum_offset 104
  .amdhsa_group_segment_fixed_size 0
  .amdhsa_kernarg_size 112
  .amdhsa_user_sgpr_count 2
  .amdhsa_user_sgpr_kernarg_segment_ptr 1
  .amdhsa_system_sgpr_workgroup_id_x 1
  .amdhsa_float_denorm_mode_32 3
  .amdhsa_float_denorm_mode_16_64 3
.end_amdhsa_kernel
.text

.section .rodata,"a"
.p2align 6
.amdhsa_kernel gem_gath_kernel
  .amdhsa_next_free_vgpr 128
  .amdhsa_next_free_sgpr 102
  .amdhsa_accum_offset 128
  .amdhsa_group_segment_fixed_size 0
  .amdhsa_kernarg_size 112
  .amdhsa_user_sgpr_count 2
  .amdhsa_user_sgpr_kernarg_segment_ptr 1
  .amdhsa_system_sgpr_workgroup_id_x 1
  .amdhsa_float_denorm_mode_32 3
  .amdhsa_float_denorm_mode_16_64 3
.end_amdhsa_kernel
.text
```
